```python
import torch

def _softmax(x, axis=-1):
    return torch.softmax(x, dim=axis)
def _gelu(x):
    return torch.nn.functional.gelu(x, approximate="tanh")
def _silu(x):
    return torch.nn.functional.silu(x)
def _sigmoid(x):
    return torch.sigmoid(x)
def _layernorm(x, axis=-1, eps=1e-5):
    m = x.mean(dim=axis, keepdim=True)
    v = x.var(dim=axis, keepdim=True, unbiased=False)
    return (x - m) / torch.sqrt(v + eps)
def _scatter_add(tgt, idx, src, axis=0):
    return tgt.clone().index_add_(axis, idx, src)
def _segment_sum(src, seg, n):
    out = torch.zeros((n,) + src.shape[1:], dtype=src.dtype)
    return out.index_add_(0, seg, src)
def _pad(x, pw):
    flat = tuple(v for pair in reversed(pw) for v in pair)
    return torch.nn.functional.pad(x, flat)

kernel_name = 'concat_heads__spectral_fnet__ssm_conv_h3__prompt'

def setup_inputs():

    _w = (lambda a: (lambda t: t.to(torch.bfloat16) if t.is_floating_point() else t)(torch.as_tensor(a)))
    def _A_setup():
        B, S, D = 1, 2048, 640
        ns = torch.arange(S)[:, None] * torch.arange(S)[None, :]
        nd = torch.arange(D)[:, None] * torch.arange(D)[None, :]
        Ws_re = torch.cos(-2.0 * torch.pi * ns / S).to(float)
        Ws_im = torch.sin(-2.0 * torch.pi * ns / S).to(float)
        Wd_re = torch.cos(-2.0 * torch.pi * nd / D).to(float)
        Wd_im = torch.sin(-2.0 * torch.pi * nd / D).to(float)
        return {
            "x": _w((lambda *s: torch.randn(*s, dtype=torch.bfloat16) * 0.05)(B, S, D)),
            "dft_seq_re": _w(Ws_re),
            "dft_seq_im": _w(Ws_im),
            "dft_hid_re": _w(Wd_re),
            "dft_hid_im": _w(Wd_im),
        }
    _A_in = _A_setup()

    def _B_setup():
        B, S, D = 1, 2048, 640
        ks = 4
        return {
            "q": _w((lambda *s: torch.randn(*s, dtype=torch.bfloat16) * 0.05)(B, S, D)),
            "k": _w((lambda *s: torch.randn(*s, dtype=torch.bfloat16) * 3.2)(B, S, D)),
            "v": _w((lambda *s: torch.randn(*s, dtype=torch.bfloat16) * 3.2)(B, S, D)),
            "shift_k": _w((lambda *s: torch.randn(*s, dtype=torch.bfloat16) * 3.2)(D, ks) * 0.5),
            "ssm_k": _w((lambda *s: torch.randn(*s, dtype=torch.bfloat16) * 3.2)(D, S) * (1.0 / S ** 0.5)),
            "ssm_D": _w((lambda *s: torch.randn(*s, dtype=torch.bfloat16) * 3.2)(D)),
        }
    _B_in = _B_setup()

    return {
        "A_x": _A_in["x"],
        "A_dft_seq_re": _A_in["dft_seq_re"],
        "A_dft_seq_im": _A_in["dft_seq_im"],
        "A_dft_hid_re": _A_in["dft_hid_re"],
        "A_dft_hid_im": _A_in["dft_hid_im"],
        "B_q": _B_in["q"],
        "B_k": _B_in["k"],
        "B_v": _B_in["v"],
        "B_shift_k": _B_in["shift_k"],
        "B_ssm_k": _B_in["ssm_k"],
        "B_ssm_D": _B_in["ssm_D"],
    }

def reference(A_x, A_dft_seq_re, A_dft_seq_im, A_dft_hid_re, A_dft_hid_im, B_q, B_k, B_v, B_shift_k, B_ssm_k, B_ssm_D):
    def _A_ref(x, dft_seq_re, dft_seq_im, dft_hid_re, dft_hid_im):
        a = torch.einsum("bsd,ed->bse", x, dft_hid_re)
        b = torch.einsum("bsd,ed->bse", x, dft_hid_im)
        y = torch.einsum("ts,bse->bte", dft_seq_re, a) - torch.einsum("ts,bse->bte", dft_seq_im, b)
        return y

    def _B_ref(q, k, v, shift_k, ssm_k, ssm_D):
        B, S, D = q.shape
        ks = shift_k.shape[-1]
        k_pad = _pad(k, ((0, 0), (ks - 1, 0), (0, 0)))
        k_shift = torch.zeros_like(k)
        for t in range(ks):
            k_shift = k_shift + k_pad[:, t:t + S, :] * shift_k[:, ks - 1 - t][None, None, :]
        kv = k_shift * v
        L = 2 * S
        kv_pad = _pad(kv, ((0, 0), (0, S), (0, 0)))
        kf_pad = _pad(ssm_k, ((0, 0), (0, S)))
        kv_f = (lambda x, axes=(-2,-1): torch.fft.rfft2(x.float(), dim=axes))(kv_pad[:, None, :, :], axes=(1, 2))
        kf_f = (lambda x, axes=(-2,-1): torch.fft.rfft2(x.float(), dim=axes))(kf_pad[:, None, :], axes=(1, 2))
        kf_f = (lambda x, *d: x.permute(*d))(kf_f, 1, 2, 0)
        y_f = kv_f * kf_f[None, :, :, :]
        y = (lambda x, s, axes=(-2,-1): torch.fft.irfft2(x, s=s, dim=axes).to(torch.bfloat16))(y_f, (1, L), axes=(1, 2))[:, 0, :S, :]
        y = y + kv * ssm_D[None, None, :]
        return q * y

    a = _A_ref(A_x, A_dft_seq_re, A_dft_seq_im, A_dft_hid_re, A_dft_hid_im)
    b = _B_ref(B_q, B_k, B_v, B_shift_k, B_ssm_k, B_ssm_D)
    return torch.concatenate([a, b], axis=-1)
```

```asm
; @launch grid=(256,1,1) block=(512,1,1) lds=119376
.amdgcn_target "amdgcn-amd-amdhsa--gfx950"
.text
.globl concat_heads__spectral_fnet__ssm_conv_h3__prompt_kernel
.p2align 8
.type concat_heads__spectral_fnet__ssm_conv_h3__prompt_kernel,@function
concat_heads__spectral_fnet__ssm_conv_h3__prompt_kernel:
    s_load_dwordx8 s[40:47], s[0:1], 40
    s_load_dwordx2 s[4:5], s[0:1], 0
    s_load_dwordx4 s[48:51], s[0:1], 72
    s_load_dwordx4 s[8:11], s[0:1], 88
    s_load_dwordx2 s[6:7], s[0:1], 104
    v_lshrrev_b32 v2, 6, v0
    v_and_b32 v1, 63, v0
    v_readfirstlane_b32 s3, v2
    s_cmp_ge_u32 s2, 256
    s_cbranch_scc1 K_end
    s_and_b32 s24, s2, 120
    s_cbranch_scc1 K_nopf
    s_getpc_b64 s[24:25]
    v_lshlrev_b32 v4, 7, v0
    v_mov_b32 v5, s25
    v_add_co_u32 v4, vcc, s24, v4
    s_nop 1
    v_addc_co_u32 v5, vcc, 0, v5, vcc
    v_cmp_gt_u32 vcc, (K_end-concat_heads__spectral_fnet__ssm_conv_h3__prompt_kernel)/128-1, v0
    s_nop 0
    s_and_saveexec_b64 s[24:25], vcc
    s_cbranch_execz K_nopf
    global_load_dword v223, v[4:5], off
K_nopf:
    s_mov_b64 exec, -1
    s_and_b32 s30, s2, 7
    s_lshr_b32 s29, s2, 3
    s_lshl_b32 s31, s30, 3
    s_mov_b32 s32, 0x10008840
    s_mov_b32 s33, 0x30208948
    s_lshr_b64 s[32:33], s[32:33], s31
    s_and_b32 s32, s32, 0xff
    s_mov_b32 s34, 0x20200018
    s_mov_b32 s35, 0x20200018
    s_lshr_b64 s[34:35], s[34:35], s31
    s_and_b32 s34, s34, 0xff
    s_add_u32 s28, s32, s29
    s_sub_u32 s28, s28, 16
    s_cmp_lt_u32 s29, 16
    s_cbranch_scc1 K_b
    s_cmp_ge_u32 s32, 128
    s_cbranch_scc1 K_b1
    s_cmp_lt_u32 s29, s34
    s_cbranch_scc1 K_a
    s_cmp_lg_u32 s2, 192
    s_cbranch_scc1 K_end
    s_cmp_lg_u32 s3, 0
    s_cbranch_scc1 K_end
    s_memrealtime s[32:33]
    v_mov_b32 v5, 0
    s_waitcnt lgkmcnt(0)
    s_or_b32 s32, s32, 1
    v_mov_b32 v4, s32
    s_mov_b64 exec, 1
    s_mov_b32 s20, s10
    s_and_b32 s21, s11, 0xffff
    s_mov_b32 s22, 0x100
    s_mov_b32 s23, 0x00020000
    buffer_store_dword v4, v5, s[20:23], 0 offen sc1
    s_endpgm
K_b1:
    s_and_b32 s30, s32, 15
    s_sub_u32 s29, s29, 16
K_b:
    s_mul_i32 s31, s29, 163840
    s_lshl_b32 s32, s30, 7
    s_add_u32 s31, s31, s32
    s_mul_i32 s32, s3, 20480
    s_add_u32 s32, s32, s31
    s_add_u32 s33, s32, 10240
    v_lshrrev_b32 v2, 3, v1
    v_mul_u32_u24 v4, 1280, v2
    v_and_b32 v3, 7, v1
    v_lshl_add_u32 v4, v3, 4, v4
    s_mul_i32 s34, s3, 2080
    s_add_u32 m0, s34, 86096
    s_mov_b32 s26, 2621440
    s_mov_b32 s27, 0x00020000
    s_mov_b32 s54, 2621440
    s_mov_b32 s55, 0x00020000
    v_and_b32 v5, 3, v2
    s_lshl_b32 s35, s3, 2
    v_add_u32 v5, s35, v5
    v_lshrrev_b32 v6, 5, v1
    v_lshl_add_u32 v6, v6, 3, v3
    v_lshlrev_b32 v7, 4, v5
    s_waitcnt lgkmcnt(0)
    s_mov_b32 s24, s42
    s_and_b32 s25, s43, 0xffff
    buffer_load_dwordx4 v4, s[24:27], s32 offen nt lds
    s_add_u32 m0, m0, 1040
    s_mov_b32 s52, s44
    buffer_load_dwordx4 v4, s[24:27], s33 offen nt lds
    s_add_u32 m0, m0, 15600
    s_and_b32 s53, s45, 0xffff
    buffer_load_dwordx4 v4, s[52:55], s32 offen nt lds
    s_add_u32 m0, m0, 1040
    s_cmp_lg_u32 s3, 3
    buffer_load_dwordx4 v4, s[52:55], s33 offen nt lds
    s_cbranch_scc1 B1_nohalo
    s_mov_b32 m0, 85056
    s_sub_u32 s35, s31, 10240
    v_add_u32 v8, s35, v4
    buffer_load_dwordx4 v8, s[24:27], 0 offen nt lds
B1_nohalo:
    s_mov_b32 s12, s6
    s_and_b32 s13, s7, 0xffff
    s_mov_b32 s14, 0x1000000
    s_mov_b32 s15, 0x00020000
    s_mov_b32 s16, s8
    s_and_b32 s17, s9, 0xffff
    s_mov_b32 s18, 0x500000
    s_mov_b32 s19, 0x00020000
    s_mov_b32 s20, s10
    s_and_b32 s21, s11, 0xffff
    s_mov_b32 s22, 0x100
    s_mov_b32 s23, 0x00020000
    s_mov_b32 s4, s46
    s_and_b32 s5, s47, 0xffff
    s_mov_b32 s6, 0x1400
    s_mov_b32 s7, 0x00020000
    s_lshl_b32 s35, s30, 9
    buffer_load_dwordx4 v[8:11], v7, s[4:7], s35 offen nt
    s_lshl_b32 s28, s30, 4
    s_add_u32 s28, s28, s29
    s_lshl_b32 s36, s28, 14
    v_lshlrev_b32 v14, 4, v1
    s_lshl_b32 s32, s28, 3
    s_and_b32 s37, s3, 2
    s_lshl_b32 s37, s37, 1
    s_add_u32 s32, s32, s37
    s_load_dword s37, s[50:51], s32
    s_lshl_b32 s34, s30, 10
    s_add_u32 s34, s34, 6881280
    s_and_b32 s33, s3, 3
    s_lshl_b32 s43, s33, 12
    s_add_u32 s43, s43, s36
    s_mul_i32 s42, s33, 16640
    s_add_u32 s42, s42, 18496
    s_mul_i32 s44, s33, 4608
    s_add_u32 s44, s44, 576
    v_mul_u32_u24 v12, 1040, v6
    v_lshl_add_u32 v12, v5, 2, v12
    v_add_u32 v12, 85056, v12
    v_lshlrev_b32 v13, 13, v5
    v_lshl_add_u32 v13, v6, 4, v13
    s_lshl_b32 s38, s30, 18
    s_lshl_b32 s39, s29, 8
    s_add_u32 s38, s38, s39
    s_add_u32 s39, s38, 4096
    s_mov_b32 s35, 0xffff0000
    v_mov_b32 v24, 0
    v_mov_b32 v18, 0
    v_and_b32 v2, 15, v1
    v_lshrrev_b32 v3, 4, v1
    s_mov_b32 s56, s48
    s_and_b32 s57, s49, 0xffff
    s_mov_b32 s58, 0x280000
    s_mov_b32 s59, 0x00020000
    s_barrier
    s_cmp_ge_u32 s3, 4
    s_cbranch_scc1 B1_noh
    s_add_u32 m0, s42, 32
    s_nop 0
    buffer_load_dwordx4 v14, s[56:59], s43 offen offset:0 nt lds
    buffer_load_dwordx4 v14, s[56:59], s43 offen offset:1024 nt lds
    buffer_load_dwordx4 v14, s[56:59], s43 offen offset:2048 nt lds
    buffer_load_dwordx4 v14, s[56:59], s43 offen offset:3072 nt lds
B1_noh:
    s_mov_b32 s24, s40
    s_and_b32 s25, s41, 0xffff
    s_mov_b32 s26, 0x280000
    s_mov_b32 s27, 0x00020000
    v_lshrrev_b32 v5, 3, v0
    v_and_b32 v6, 7, v1
    v_mul_u32_u24 v20, 2080, v6
    v_lshl_add_u32 v20, v5, 2, v20
    v_add_u32 v20, 85056, v20
    v_and_b32 v7, 1, v5
    v_lshlrev_b32 v7, 1, v7
    v_bfe_u32 v15, v5, 1, 1
    v_lshl_add_u32 v7, v15, 8, v7
    v_bfe_u32 v15, v5, 2, 2
    v_lshl_add_u32 v7, v15, 4, v7
    v_lshrrev_b32 v15, 4, v5
    v_lshl_add_u32 v7, v15, 2, v7
    v_mul_u32_u24 v21, 1280, v7
    v_lshl_add_u32 v21, v6, 4, v21
    v_mul_u32_u24 v22, 2560, v7
    v_lshl_add_u32 v22, v6, 4, v22
    s_lshr_b32 s45, s29, 2
    s_lshl_b32 s45, s45, 3
    s_and_b32 s46, s29, 3
    s_add_u32 s45, s45, s46
    s_mul_i32 s45, s45, 81920
    s_lshl_b32 s46, s30, 7
    s_lshl_b32 s47, s45, 1
    s_add_u32 s45, s45, s46
    s_add_u32 s47, s47, s46
    s_add_u32 s47, s47, 1280
    v_lshlrev_b32 v23, 12, v3
    v_lshl_add_u32 v23, v2, 4, v23
    s_cmp_lt_u32 s3, 4
    s_cbranch_scc1 B1_m
    s_waitcnt vmcnt(0)
    s_branch B1_w
B1_m:
    v_mov_b32 v25, 0
    v_mov_b32 v26, 0
    v_mov_b32 v27, 0
    v_subrev_u32 v5, 512, v14
    v_add_u32 v5, s44, v5
    v_subrev_u32 v6, 32, v1
    v_lshrrev_b32 v7, 1, v6
    v_mul_u32_u24 v7, 4160, v7
    v_and_b32 v6, 1, v6
    v_lshl_add_u32 v7, v6, 4, v7
    v_add_u32 v7, s42, v7
    v_cmp_gt_u32 vcc, 32, v1
    s_mov_b32 exec_hi, 0xff
    s_nop 0
    v_cndmask_b32 v5, v7, v5, vcc
    ds_write_b128 v5, v[24:27]
    s_mov_b64 exec, 3
    ds_write_b128 v14, v[24:27]
    s_mov_b64 exec, -1
    v_lshl_add_u32 v18, v3, 3, v2
    v_add_u32 v5, 1, v18
    v_sub_u32 v19, 0, v5
    v_and_b32 v19, 3, v19
    v_add_u32 v5, v5, v19
    v_mul_u32_u24 v19, 4160, v19
    v_lshl_add_u32 v16, v5, 1, v19
    v_add_u32 v16, s42, v16
    v_lshlrev_b32 v17, 5, v2
    v_lshlrev_b32 v5, 4, v3
    v_sub_u32 v17, v17, v5
    s_add_u32 s32, s44, 16
    v_add_u32 v17, s32, v17
    v_sub_u32 v6, 15, v18
    v_and_b32 v7, 1, v6
    v_lshlrev_b32 v7, 4, v7
    v_ashrrev_i32 v6, 1, v6
    v_lshrrev_b32 v5, 2, v2
    v_lshlrev_b32 v5, 8, v5
    v_lshl_add_u32 v5, v3, 6, v5
    v_and_b32 v19, 3, v2
    v_lshl_add_u32 v18, v19, 4, v5
    v_add_u32 v19, s42, v14
    s_waitcnt lgkmcnt(0)
    v_mov_b32 v25, 1
    s_lshl_b32 s32, s3, 2
    v_mov_b32 v26, s32
    s_lshr_b32 s32, s37, 16
    s_and_b32 s37, s37, 0xffff
    s_bitcmp1_b32 s3, 0
    s_cselect_b32 s37, s32, s37
    v_lshlrev_b32 v7, v7, s37
    v_cmp_eq_u32 vcc, 0, v6
    s_nop 1
    v_cndmask_b32 v188, v24, v7, vcc
    v_cmp_eq_u32 vcc, 1, v6
    s_nop 1
    v_cndmask_b32 v189, v24, v7, vcc
    v_cmp_eq_u32 vcc, 2, v6
    s_nop 1
    v_cndmask_b32 v190, v24, v7, vcc
    v_cmp_eq_u32 vcc, 3, v6
    s_nop 1
    v_cndmask_b32 v191, v24, v7, vcc
    s_mov_b32 m0, s44
    s_waitcnt vmcnt(4)
    v_lshlrev_b32 v204, 7, v1
    s_mov_b32 exec_hi, 0
    s_mov_b32 s32, 802
    s_bitcmp1_b32 s32, s30
    s_cbranch_scc1 B1_hy1
    buffer_load_dword v200, v204, s[12:15], s43 offen nt
    s_branch B1_hy2
B1_hy1:
    buffer_load_dword v200, v204, s[12:15], s43 offen
B1_hy2:
    s_mov_b64 exec, -1
    s_mov_b64 exec, 15
    buffer_load_dword v201, v204, s[12:15], s34 offen
    s_mov_b64 exec, -1
B1_w:
    v_lshlrev_b32 v28, 16, v8
    v_and_b32 v30, s35, v8
    v_lshlrev_b32 v32, 16, v9
    v_and_b32 v34, s35, v9
    v_lshlrev_b32 v29, 16, v10
    v_and_b32 v31, s35, v10
    v_lshlrev_b32 v33, 16, v11
    v_and_b32 v35, s35, v11
    s_barrier
    ds_read_b32 v36, v12 offset:640
    ds_read_b32 v37, v12 offset:768
    ds_read_b32 v38, v12 offset:896
    ds_read_b32 v39, v12 offset:1040
    ds_read_b32 v40, v12 offset:1168
    ds_read_b32 v41, v12 offset:1296
    ds_read_b32 v42, v12 offset:1424
    ds_read_b32 v43, v12 offset:1552
    ds_read_b32 v44, v12 offset:1680
    ds_read_b32 v45, v12 offset:1808
    ds_read_b32 v46, v12 offset:1936
    s_waitcnt lgkmcnt(4)
    ds_read_b32 v48, v12 offset:17680
    ds_read_b32 v49, v12 offset:17808
    ds_read_b32 v50, v12 offset:17936
    ds_read_b32 v51, v12 offset:18064
    ds_read_b32 v52, v12 offset:18192
    ds_read_b32 v53, v12 offset:18320
    ds_read_b32 v54, v12 offset:18448
    ds_read_b32 v55, v12 offset:18576
    v_lshlrev_b32 v56, 16, v36
    v_and_b32 v57, s35, v36
    v_lshlrev_b32 v58, 16, v37
    v_and_b32 v59, s35, v37
    v_lshlrev_b32 v60, 16, v38
    v_and_b32 v61, s35, v38
    v_lshlrev_b32 v62, 16, v39
    v_and_b32 v63, s35, v39
    v_lshlrev_b32 v64, 16, v40
    v_and_b32 v65, s35, v40
    v_lshlrev_b32 v66, 16, v41
    v_and_b32 v67, s35, v41
    v_lshlrev_b32 v68, 16, v42
    v_and_b32 v69, s35, v42
    s_waitcnt lgkmcnt(8)
    v_lshlrev_b32 v70, 16, v43
    v_and_b32 v71, s35, v43
    v_lshlrev_b32 v72, 16, v44
    v_and_b32 v73, s35, v44
    v_lshlrev_b32 v74, 16, v45
    v_and_b32 v75, s35, v45
    v_lshlrev_b32 v76, 16, v46
    v_and_b32 v77, s35, v46
    v_pk_mul_f32 v[96:97], v[34:35], v[56:57]
    v_pk_mul_f32 v[98:99], v[34:35], v[58:59]
    v_pk_mul_f32 v[100:101], v[34:35], v[60:61]
    v_pk_mul_f32 v[102:103], v[34:35], v[62:63]
    v_pk_mul_f32 v[104:105], v[34:35], v[64:65]
    v_pk_mul_f32 v[106:107], v[34:35], v[66:67]
    v_pk_mul_f32 v[108:109], v[34:35], v[68:69]
    v_pk_mul_f32 v[110:111], v[34:35], v[70:71]
    v_pk_fma_f32 v[96:97], v[32:33], v[58:59], v[96:97]
    v_pk_fma_f32 v[98:99], v[32:33], v[60:61], v[98:99]
    v_pk_fma_f32 v[100:101], v[32:33], v[62:63], v[100:101]
    v_pk_fma_f32 v[102:103], v[32:33], v[64:65], v[102:103]
    v_pk_fma_f32 v[104:105], v[32:33], v[66:67], v[104:105]
    v_pk_fma_f32 v[106:107], v[32:33], v[68:69], v[106:107]
    v_pk_fma_f32 v[108:109], v[32:33], v[70:71], v[108:109]
    v_pk_fma_f32 v[110:111], v[32:33], v[72:73], v[110:111]
    v_pk_fma_f32 v[96:97], v[30:31], v[60:61], v[96:97]
    v_pk_fma_f32 v[98:99], v[30:31], v[62:63], v[98:99]
    v_pk_fma_f32 v[100:101], v[30:31], v[64:65], v[100:101]
    v_pk_fma_f32 v[102:103], v[30:31], v[66:67], v[102:103]
    v_pk_fma_f32 v[104:105], v[30:31], v[68:69], v[104:105]
    v_pk_fma_f32 v[106:107], v[30:31], v[70:71], v[106:107]
    v_pk_fma_f32 v[108:109], v[30:31], v[72:73], v[108:109]
    v_pk_fma_f32 v[110:111], v[30:31], v[74:75], v[110:111]
    v_pk_fma_f32 v[96:97], v[28:29], v[62:63], v[96:97]
    v_pk_fma_f32 v[98:99], v[28:29], v[64:65], v[98:99]
    v_pk_fma_f32 v[100:101], v[28:29], v[66:67], v[100:101]
    v_pk_fma_f32 v[102:103], v[28:29], v[68:69], v[102:103]
    v_pk_fma_f32 v[104:105], v[28:29], v[70:71], v[104:105]
    v_pk_fma_f32 v[106:107], v[28:29], v[72:73], v[106:107]
    v_pk_fma_f32 v[108:109], v[28:29], v[74:75], v[108:109]
    v_pk_fma_f32 v[110:111], v[28:29], v[76:77], v[110:111]
    s_waitcnt lgkmcnt(0)
    s_load_dword s60, s[10:11], 0
    v_lshlrev_b32 v80, 16, v48
    v_and_b32 v81, s35, v48
    v_lshlrev_b32 v82, 16, v49
    v_and_b32 v83, s35, v49
    v_lshlrev_b32 v84, 16, v50
    v_and_b32 v85, s35, v50
    v_lshlrev_b32 v86, 16, v51
    v_and_b32 v87, s35, v51
    v_lshlrev_b32 v88, 16, v52
    v_and_b32 v89, s35, v52
    v_lshlrev_b32 v90, 16, v53
    v_and_b32 v91, s35, v53
    v_lshlrev_b32 v92, 16, v54
    v_and_b32 v93, s35, v54
    v_lshlrev_b32 v94, 16, v55
    v_and_b32 v95, s35, v55
    v_pk_mul_f32 v[96:97], v[96:97], v[80:81]
    v_pk_mul_f32 v[98:99], v[98:99], v[82:83]
    v_pk_mul_f32 v[100:101], v[100:101], v[84:85]
    v_pk_mul_f32 v[102:103], v[102:103], v[86:87]
    v_pk_mul_f32 v[104:105], v[104:105], v[88:89]
    v_pk_mul_f32 v[106:107], v[106:107], v[90:91]
    v_pk_mul_f32 v[108:109], v[108:109], v[92:93]
    v_pk_mul_f32 v[110:111], v[110:111], v[94:95]
    v_cvt_pk_bf16_f32 v112, v110, v108
    v_cvt_pk_bf16_f32 v113, v106, v104
    v_cvt_pk_bf16_f32 v114, v102, v100
    v_cvt_pk_bf16_f32 v115, v98, v96
    buffer_store_dwordx4 v[112:115], v13, s[12:15], s38 offen
    v_cvt_pk_bf16_f32 v116, v111, v109
    v_cvt_pk_bf16_f32 v117, v107, v105
    v_cvt_pk_bf16_f32 v118, v103, v101
    v_cvt_pk_bf16_f32 v119, v99, v97
    buffer_store_dwordx4 v[116:119], v13, s[12:15], s39 offen
    s_cmp_ge_u32 s3, 4
    s_cbranch_scc1 B_help
    s_waitcnt vmcnt(4)
    ds_read_b64 v[28:29], v19 offset:24
    ds_read_b128 v[30:33], v19 offset:32
    ds_read_b64 v[34:35], v19 offset:1048
    ds_read_b128 v[36:39], v19 offset:1056
    ds_read_b64 v[40:41], v19 offset:2072
    ds_read_b128 v[42:45], v19 offset:2080
    ds_read_b64 v[46:47], v19 offset:3096
    ds_read_b128 v[48:51], v19 offset:3104
    s_waitcnt lgkmcnt(6)
    v_alignbit_b32 v56, v30, v29, 16
    v_alignbit_b32 v57, v31, v30, 16
    v_alignbit_b32 v58, v32, v31, 16
    v_alignbit_b32 v59, v33, v32, 16
    ds_write_b128 v19, v[56:59] offset:4192
    v_mov_b32 v60, v29
    v_mov_b32 v61, v30
    v_mov_b32 v62, v31
    v_mov_b32 v63, v32
    ds_write_b128 v19, v[60:63] offset:8352
    v_alignbit_b32 v64, v29, v28, 16
    v_alignbit_b32 v65, v30, v29, 16
    v_alignbit_b32 v66, v31, v30, 16
    v_alignbit_b32 v67, v32, v31, 16
    ds_write_b128 v19, v[64:67] offset:12512
    s_waitcnt lgkmcnt(3)
    v_alignbit_b32 v68, v36, v35, 16
    v_alignbit_b32 v69, v37, v36, 16
    v_alignbit_b32 v70, v38, v37, 16
    v_alignbit_b32 v71, v39, v38, 16
    ds_write_b128 v19, v[68:71] offset:5216
    v_mov_b32 v72, v35
    v_mov_b32 v73, v36
    v_mov_b32 v74, v37
    v_mov_b32 v75, v38
    ds_write_b128 v19, v[72:75] offset:9376
    v_alignbit_b32 v76, v35, v34, 16
    v_alignbit_b32 v77, v36, v35, 16
    v_alignbit_b32 v78, v37, v36, 16
    v_alignbit_b32 v79, v38, v37, 16
    ds_write_b128 v19, v[76:79] offset:13536
    s_waitcnt vmcnt(0)
    s_barrier
    v_alignbit_b32 v80, v42, v41, 16
    v_alignbit_b32 v81, v43, v42, 16
    v_alignbit_b32 v82, v44, v43, 16
    v_alignbit_b32 v83, v45, v44, 16
    ds_write_b128 v19, v[80:83] offset:6240
    v_mov_b32 v84, v41
    v_mov_b32 v85, v42
    v_mov_b32 v86, v43
    v_mov_b32 v87, v44
    ds_write_b128 v19, v[84:87] offset:10400
    v_alignbit_b32 v88, v41, v40, 16
    v_alignbit_b32 v89, v42, v41, 16
    v_alignbit_b32 v90, v43, v42, 16
    v_alignbit_b32 v91, v44, v43, 16
    ds_write_b128 v19, v[88:91] offset:14560
    v_alignbit_b32 v92, v48, v47, 16
    v_alignbit_b32 v93, v49, v48, 16
    v_alignbit_b32 v94, v50, v49, 16
    v_alignbit_b32 v95, v51, v50, 16
    ds_write_b128 v19, v[92:95] offset:7264
    v_mov_b32 v96, v47
    v_mov_b32 v97, v48
    v_mov_b32 v98, v49
    v_mov_b32 v99, v50
    ds_write_b128 v19, v[96:99] offset:11424
    v_alignbit_b32 v100, v47, v46, 16
    v_alignbit_b32 v101, v48, v47, 16
    v_alignbit_b32 v102, v49, v48, 16
    v_alignbit_b32 v103, v50, v49, 16
    ds_write_b128 v19, v[100:103] offset:15584
    s_waitcnt lgkmcnt(0)
    ds_read_b64 v[48:49], v16 offset:0
    ds_read_b64 v[50:51], v16 offset:8
    ds_read_b64 v[52:53], v16 offset:512
    ds_read_b64 v[54:55], v16 offset:520
    ds_read_b64 v[56:57], v16 offset:1024
    ds_read_b64 v[58:59], v16 offset:1032
    ds_read_b64 v[60:61], v16 offset:1536
    ds_read_b64 v[62:63], v16 offset:1544
    ds_read_b64 v[64:65], v16 offset:2048
    ds_read_b64 v[66:67], v16 offset:2056
    ds_read_b64 v[68:69], v16 offset:2560
    ds_read_b64 v[70:71], v16 offset:2568
    s_waitcnt lgkmcnt(8)
    ds_read_b64 v[72:73], v16 offset:3072
    ds_read_b64 v[74:75], v16 offset:3080
    ds_read_b64 v[76:77], v16 offset:3584
    ds_read_b64 v[78:79], v16 offset:3592
    s_lshl_b32 s38, s30, 18
    s_lshl_b32 s39, s29, 8
    s_add_u32 s38, s38, s39
    s_lshl_b32 s39, s3, 15
    s_add_u32 s38, s38, s39
    s_mul_i32 s39, s3, 2080
    s_add_u32 s39, s39, 85056
    v_add_u32 v19, s39, v14
    s_barrier
    buffer_load_dwordx4 v14, s[12:15], s43 offen offset:0 sc1 lds
    buffer_load_dwordx4 v14, s[12:15], s43 offen offset:1024 sc1 lds
    buffer_load_dwordx4 v14, s[12:15], s43 offen offset:2048 sc1 lds
    buffer_load_dwordx4 v14, s[12:15], s43 offen offset:3072 sc1 lds
    ds_read_b32 v4, v24
    s_waitcnt lgkmcnt(0)
    v_readfirstlane_b32 s48, v4
    s_nop 0
    s_cmp_eq_u32 s48, 0
    s_cbranch_scc1 B_fast1
    s_add_u32 s32, s43, 8388608
    s_waitcnt vmcnt(0)
    buffer_load_dwordx4 v14, s[12:15], s32 offen offset:0 sc1 lds
    buffer_load_dwordx4 v14, s[12:15], s32 offen offset:1024 sc1 lds
    buffer_load_dwordx4 v14, s[12:15], s32 offen offset:2048 sc1 lds
    buffer_load_dwordx4 v14, s[12:15], s32 offen offset:3072 sc1 lds
B_fast1:
    s_waitcnt vmcnt(3)
    ds_read_b128 v[80:83], v17 offset:0
    ds_read_b128 v[84:87], v17 offset:512
    s_waitcnt vmcnt(2)
    ds_read_b128 v[88:91], v17 offset:1024
    ds_read_b128 v[92:95], v17 offset:1536
    s_waitcnt lgkmcnt(2)
    v_mfma_f32_16x16x32_bf16 v[192:195], v[188:191], v[80:83], 0
    v_mfma_f32_16x16x32_bf16 v[192:195], v[48:51], v[80:83], v[192:195]
    s_waitcnt vmcnt(1)
    ds_read_b128 v[96:99], v17 offset:2048
    ds_read_b128 v[100:103], v17 offset:2560
    v_mfma_f32_16x16x32_bf16 v[196:199], v[188:191], v[84:87], 0
    v_mfma_f32_16x16x32_bf16 v[196:199], v[48:51], v[84:87], v[196:199]
    v_mfma_f32_16x16x32_bf16 v[196:199], v[52:55], v[80:83], v[196:199]
    s_waitcnt lgkmcnt(2)
    v_mfma_f32_16x16x32_bf16 v[200:203], v[188:191], v[88:91], 0
    v_mfma_f32_16x16x32_bf16 v[200:203], v[48:51], v[88:91], v[200:203]
    s_waitcnt vmcnt(0)
    ds_read_b128 v[104:107], v17 offset:3072
    ds_read_b128 v[108:111], v17 offset:3584
    v_mfma_f32_16x16x32_bf16 v[200:203], v[52:55], v[84:87], v[200:203]
    ds_write_b32 v26, v25 offset:16
    v_mfma_f32_16x16x32_bf16 v[200:203], v[56:59], v[80:83], v[200:203]
    v_add_u32 v16, 64, v16
    v_mfma_f32_16x16x32_bf16 v[204:207], v[188:191], v[92:95], 0
    v_subrev_u32 v17, 64, v17
    v_mfma_f32_16x16x32_bf16 v[204:207], v[48:51], v[92:95], v[204:207]
    v_mfma_f32_16x16x32_bf16 v[204:207], v[52:55], v[88:91], v[204:207]
    v_mfma_f32_16x16x32_bf16 v[204:207], v[56:59], v[84:87], v[204:207]
    v_mfma_f32_16x16x32_bf16 v[204:207], v[60:63], v[80:83], v[204:207]
    s_waitcnt lgkmcnt(0)
    v_mfma_f32_16x16x32_bf16 v[208:211], v[188:191], v[96:99], 0
    ds_read_b128 v[144:147], v17 offset:0
    v_mfma_f32_16x16x32_bf16 v[208:211], v[48:51], v[96:99], v[208:211]
    ds_read_b64 v[112:113], v16 offset:0
    v_mfma_f32_16x16x32_bf16 v[208:211], v[52:55], v[92:95], v[208:211]
    ds_read_b64 v[114:115], v16 offset:8
    v_mfma_f32_16x16x32_bf16 v[208:211], v[56:59], v[88:91], v[208:211]
    ds_read_b128 v[148:151], v17 offset:512
    v_mfma_f32_16x16x32_bf16 v[208:211], v[60:63], v[84:87], v[208:211]
    ds_read_b64 v[116:117], v16 offset:512
    v_mfma_f32_16x16x32_bf16 v[208:211], v[64:67], v[80:83], v[208:211]
    ds_read_b64 v[118:119], v16 offset:520
    v_mfma_f32_16x16x32_bf16 v[212:215], v[188:191], v[100:103], 0
    ds_read_b128 v[152:155], v17 offset:1024
    v_mfma_f32_16x16x32_bf16 v[212:215], v[48:51], v[100:103], v[212:215]
    ds_read_b64 v[120:121], v16 offset:1024
    v_mfma_f32_16x16x32_bf16 v[212:215], v[52:55], v[96:99], v[212:215]
    ds_read_b64 v[122:123], v16 offset:1032
    v_mfma_f32_16x16x32_bf16 v[212:215], v[56:59], v[92:95], v[212:215]
    ds_read_b128 v[156:159], v17 offset:1536
    v_mfma_f32_16x16x32_bf16 v[212:215], v[60:63], v[88:91], v[212:215]
    ds_read_b64 v[124:125], v16 offset:1536
    v_mfma_f32_16x16x32_bf16 v[212:215], v[64:67], v[84:87], v[212:215]
    ds_read_b64 v[126:127], v16 offset:1544
    v_mfma_f32_16x16x32_bf16 v[212:215], v[68:71], v[80:83], v[212:215]
    ds_read_b128 v[160:163], v17 offset:2048
    v_mfma_f32_16x16x32_bf16 v[216:219], v[188:191], v[104:107], 0
    ds_read_b64 v[128:129], v16 offset:2048
    v_mfma_f32_16x16x32_bf16 v[216:219], v[48:51], v[104:107], v[216:219]
    ds_read_b64 v[130:131], v16 offset:2056
    v_mfma_f32_16x16x32_bf16 v[216:219], v[52:55], v[100:103], v[216:219]
    ds_read_b128 v[164:167], v17 offset:2560
    v_mfma_f32_16x16x32_bf16 v[216:219], v[56:59], v[96:99], v[216:219]
    ds_read_b64 v[132:133], v16 offset:2560
    v_mfma_f32_16x16x32_bf16 v[216:219], v[60:63], v[92:95], v[216:219]
    ds_read_b64 v[134:135], v16 offset:2568
    v_mfma_f32_16x16x32_bf16 v[216:219], v[64:67], v[88:91], v[216:219]
    ds_read_b128 v[168:171], v17 offset:3072
    v_mfma_f32_16x16x32_bf16 v[216:219], v[68:71], v[84:87], v[216:219]
    ds_read_b64 v[136:137], v16 offset:3072
    v_mfma_f32_16x16x32_bf16 v[216:219], v[72:75], v[80:83], v[216:219]
    ds_read_b64 v[138:139], v16 offset:3080
    v_mfma_f32_16x16x32_bf16 v[220:223], v[188:191], v[108:111], 0
    ds_read_b128 v[172:175], v17 offset:3584
    v_mfma_f32_16x16x32_bf16 v[220:223], v[48:51], v[108:111], v[220:223]
    ds_read_b64 v[140:141], v16 offset:3584
    v_mfma_f32_16x16x32_bf16 v[220:223], v[52:55], v[104:107], v[220:223]
    ds_read_b64 v[142:143], v16 offset:3592
    v_mfma_f32_16x16x32_bf16 v[220:223], v[56:59], v[100:103], v[220:223]
    v_add_u32 v16, 64, v16
    v_mfma_f32_16x16x32_bf16 v[220:223], v[60:63], v[96:99], v[220:223]
    v_subrev_u32 v17, 64, v17
    v_mfma_f32_16x16x32_bf16 v[220:223], v[64:67], v[92:95], v[220:223]
    buffer_load_dwordx4 v[176:179], v21, s[24:27], s45 offen offset:0 nt
    v_mfma_f32_16x16x32_bf16 v[220:223], v[68:71], v[88:91], v[220:223]
    buffer_load_dwordx4 v[180:183], v21, s[24:27], s45 offen offset:1280 nt
    v_mfma_f32_16x16x32_bf16 v[220:223], v[72:75], v[84:87], v[220:223]
    v_mfma_f32_16x16x32_bf16 v[220:223], v[76:79], v[80:83], v[220:223]
    s_waitcnt lgkmcnt(0)
    s_mov_b32 s33, 0
    .p2align 3
B_g:
    v_mfma_f32_16x16x32_bf16 v[192:195], v[112:115], v[144:147], v[192:195]
    ds_read_b128 v[80:83], v17 offset:0
    v_mfma_f32_16x16x32_bf16 v[196:199], v[112:115], v[148:151], v[196:199]
    ds_read_b64 v[48:49], v16 offset:0
    v_mfma_f32_16x16x32_bf16 v[196:199], v[116:119], v[144:147], v[196:199]
    ds_read_b64 v[50:51], v16 offset:8
    v_mfma_f32_16x16x32_bf16 v[200:203], v[112:115], v[152:155], v[200:203]
    ds_read_b128 v[84:87], v17 offset:512
    v_mfma_f32_16x16x32_bf16 v[200:203], v[116:119], v[148:151], v[200:203]
    ds_read_b64 v[52:53], v16 offset:512
    v_mfma_f32_16x16x32_bf16 v[200:203], v[120:123], v[144:147], v[200:203]
    ds_read_b64 v[54:55], v16 offset:520
    v_mfma_f32_16x16x32_bf16 v[204:207], v[112:115], v[156:159], v[204:207]
    ds_read_b128 v[88:91], v17 offset:1024
    v_mfma_f32_16x16x32_bf16 v[204:207], v[116:119], v[152:155], v[204:207]
    ds_read_b64 v[56:57], v16 offset:1024
    v_mfma_f32_16x16x32_bf16 v[204:207], v[120:123], v[148:151], v[204:207]
    ds_read_b64 v[58:59], v16 offset:1032
    v_mfma_f32_16x16x32_bf16 v[204:207], v[124:127], v[144:147], v[204:207]
    ds_read_b128 v[92:95], v17 offset:1536
    v_mfma_f32_16x16x32_bf16 v[208:211], v[112:115], v[160:163], v[208:211]
    ds_read_b64 v[60:61], v16 offset:1536
    v_mfma_f32_16x16x32_bf16 v[208:211], v[116:119], v[156:159], v[208:211]
    ds_read_b64 v[62:63], v16 offset:1544
    v_mfma_f32_16x16x32_bf16 v[208:211], v[120:123], v[152:155], v[208:211]
    ds_read_b128 v[96:99], v17 offset:2048
    v_mfma_f32_16x16x32_bf16 v[208:211], v[124:127], v[148:151], v[208:211]
    ds_read_b64 v[64:65], v16 offset:2048
    v_mfma_f32_16x16x32_bf16 v[208:211], v[128:131], v[144:147], v[208:211]
    ds_read_b64 v[66:67], v16 offset:2056
    v_mfma_f32_16x16x32_bf16 v[212:215], v[112:115], v[164:167], v[212:215]
    ds_read_b128 v[100:103], v17 offset:2560
    v_mfma_f32_16x16x32_bf16 v[212:215], v[116:119], v[160:163], v[212:215]
    ds_read_b64 v[68:69], v16 offset:2560
    v_mfma_f32_16x16x32_bf16 v[212:215], v[120:123], v[156:159], v[212:215]
    ds_read_b64 v[70:71], v16 offset:2568
    v_mfma_f32_16x16x32_bf16 v[212:215], v[124:127], v[152:155], v[212:215]
    ds_read_b128 v[104:107], v17 offset:3072
    v_mfma_f32_16x16x32_bf16 v[212:215], v[128:131], v[148:151], v[212:215]
    ds_read_b64 v[72:73], v16 offset:3072
    v_mfma_f32_16x16x32_bf16 v[212:215], v[132:135], v[144:147], v[212:215]
    ds_read_b64 v[74:75], v16 offset:3080
    v_mfma_f32_16x16x32_bf16 v[216:219], v[112:115], v[168:171], v[216:219]
    ds_read_b128 v[108:111], v17 offset:3584
    v_mfma_f32_16x16x32_bf16 v[216:219], v[116:119], v[164:167], v[216:219]
    ds_read_b64 v[76:77], v16 offset:3584
    v_mfma_f32_16x16x32_bf16 v[216:219], v[120:123], v[160:163], v[216:219]
    ds_read_b64 v[78:79], v16 offset:3592
    v_mfma_f32_16x16x32_bf16 v[216:219], v[124:127], v[156:159], v[216:219]
    v_add_u32 v16, 64, v16
    v_mfma_f32_16x16x32_bf16 v[216:219], v[128:131], v[152:155], v[216:219]
    v_subrev_u32 v17, 64, v17
    v_mfma_f32_16x16x32_bf16 v[216:219], v[132:135], v[148:151], v[216:219]
    v_mfma_f32_16x16x32_bf16 v[216:219], v[136:139], v[144:147], v[216:219]
    v_mfma_f32_16x16x32_bf16 v[220:223], v[112:115], v[172:175], v[220:223]
    v_mfma_f32_16x16x32_bf16 v[220:223], v[116:119], v[168:171], v[220:223]
    v_mfma_f32_16x16x32_bf16 v[220:223], v[120:123], v[164:167], v[220:223]
    v_mfma_f32_16x16x32_bf16 v[220:223], v[124:127], v[160:163], v[220:223]
    v_mfma_f32_16x16x32_bf16 v[220:223], v[128:131], v[156:159], v[220:223]
    v_mfma_f32_16x16x32_bf16 v[220:223], v[132:135], v[152:155], v[220:223]
    v_mfma_f32_16x16x32_bf16 v[220:223], v[136:139], v[148:151], v[220:223]
    v_mfma_f32_16x16x32_bf16 v[220:223], v[140:143], v[144:147], v[220:223]
    s_waitcnt lgkmcnt(0)
    v_mfma_f32_16x16x32_bf16 v[192:195], v[48:51], v[80:83], v[192:195]
    ds_read_b128 v[144:147], v17 offset:0
    v_mfma_f32_16x16x32_bf16 v[196:199], v[48:51], v[84:87], v[196:199]
    ds_read_b64 v[112:113], v16 offset:0
    v_mfma_f32_16x16x32_bf16 v[196:199], v[52:55], v[80:83], v[196:199]
    ds_read_b64 v[114:115], v16 offset:8
    v_mfma_f32_16x16x32_bf16 v[200:203], v[48:51], v[88:91], v[200:203]
    ds_read_b128 v[148:151], v17 offset:512
    v_mfma_f32_16x16x32_bf16 v[200:203], v[52:55], v[84:87], v[200:203]
    ds_read_b64 v[116:117], v16 offset:512
    v_mfma_f32_16x16x32_bf16 v[200:203], v[56:59], v[80:83], v[200:203]
    ds_read_b64 v[118:119], v16 offset:520
    v_mfma_f32_16x16x32_bf16 v[204:207], v[48:51], v[92:95], v[204:207]
    ds_read_b128 v[152:155], v17 offset:1024
    v_mfma_f32_16x16x32_bf16 v[204:207], v[52:55], v[88:91], v[204:207]
    ds_read_b64 v[120:121], v16 offset:1024
    v_mfma_f32_16x16x32_bf16 v[204:207], v[56:59], v[84:87], v[204:207]
    ds_read_b64 v[122:123], v16 offset:1032
    v_mfma_f32_16x16x32_bf16 v[204:207], v[60:63], v[80:83], v[204:207]
    ds_read_b128 v[156:159], v17 offset:1536
    v_mfma_f32_16x16x32_bf16 v[208:211], v[48:51], v[96:99], v[208:211]
    ds_read_b64 v[124:125], v16 offset:1536
    v_mfma_f32_16x16x32_bf16 v[208:211], v[52:55], v[92:95], v[208:211]
    ds_read_b64 v[126:127], v16 offset:1544
    v_mfma_f32_16x16x32_bf16 v[208:211], v[56:59], v[88:91], v[208:211]
    ds_read_b128 v[160:163], v17 offset:2048
    v_mfma_f32_16x16x32_bf16 v[208:211], v[60:63], v[84:87], v[208:211]
    ds_read_b64 v[128:129], v16 offset:2048
    v_mfma_f32_16x16x32_bf16 v[208:211], v[64:67], v[80:83], v[208:211]
    ds_read_b64 v[130:131], v16 offset:2056
    v_mfma_f32_16x16x32_bf16 v[212:215], v[48:51], v[100:103], v[212:215]
    ds_read_b128 v[164:167], v17 offset:2560
    v_mfma_f32_16x16x32_bf16 v[212:215], v[52:55], v[96:99], v[212:215]
    ds_read_b64 v[132:133], v16 offset:2560
    v_mfma_f32_16x16x32_bf16 v[212:215], v[56:59], v[92:95], v[212:215]
    ds_read_b64 v[134:135], v16 offset:2568
    v_mfma_f32_16x16x32_bf16 v[212:215], v[60:63], v[88:91], v[212:215]
    ds_read_b128 v[168:171], v17 offset:3072
    v_mfma_f32_16x16x32_bf16 v[212:215], v[64:67], v[84:87], v[212:215]
    ds_read_b64 v[136:137], v16 offset:3072
    v_mfma_f32_16x16x32_bf16 v[212:215], v[68:71], v[80:83], v[212:215]
    ds_read_b64 v[138:139], v16 offset:3080
    v_mfma_f32_16x16x32_bf16 v[216:219], v[48:51], v[104:107], v[216:219]
    ds_read_b128 v[172:175], v17 offset:3584
    v_mfma_f32_16x16x32_bf16 v[216:219], v[52:55], v[100:103], v[216:219]
    ds_read_b64 v[140:141], v16 offset:3584
    v_mfma_f32_16x16x32_bf16 v[216:219], v[56:59], v[96:99], v[216:219]
    ds_read_b64 v[142:143], v16 offset:3592
    v_mfma_f32_16x16x32_bf16 v[216:219], v[60:63], v[92:95], v[216:219]
    v_add_u32 v16, 64, v16
    v_mfma_f32_16x16x32_bf16 v[216:219], v[64:67], v[88:91], v[216:219]
    v_subrev_u32 v17, 64, v17
    v_mfma_f32_16x16x32_bf16 v[216:219], v[68:71], v[84:87], v[216:219]
    v_mfma_f32_16x16x32_bf16 v[216:219], v[72:75], v[80:83], v[216:219]
    v_mfma_f32_16x16x32_bf16 v[220:223], v[48:51], v[108:111], v[220:223]
    v_mfma_f32_16x16x32_bf16 v[220:223], v[52:55], v[104:107], v[220:223]
    v_mfma_f32_16x16x32_bf16 v[220:223], v[56:59], v[100:103], v[220:223]
    s_add_u32 s33, s33, 1
    s_cmp_lt_u32 s33, 3
    ds_read_b32 v4, v24 offset:8
    v_mfma_f32_16x16x32_bf16 v[220:223], v[60:63], v[96:99], v[220:223]
    v_mfma_f32_16x16x32_bf16 v[220:223], v[64:67], v[92:95], v[220:223]
    v_mfma_f32_16x16x32_bf16 v[220:223], v[68:71], v[88:91], v[220:223]
    v_mfma_f32_16x16x32_bf16 v[220:223], v[72:75], v[84:87], v[220:223]
    v_mfma_f32_16x16x32_bf16 v[220:223], v[76:79], v[80:83], v[220:223]
    s_waitcnt lgkmcnt(0)
    s_cbranch_scc1 B_g
B_last:
    v_cmp_eq_u32 vcc, 0, v4
    s_cbranch_vccnz B_lastrare
B_last2:
    v_mfma_f32_16x16x32_bf16 v[192:195], v[112:115], v[144:147], v[192:195]
    v_mfma_f32_16x16x32_bf16 v[196:199], v[112:115], v[148:151], v[196:199]
    v_mfma_f32_16x16x32_bf16 v[196:199], v[116:119], v[144:147], v[196:199]
    v_mfma_f32_16x16x32_bf16 v[200:203], v[112:115], v[152:155], v[200:203]
    v_mfma_f32_16x16x32_bf16 v[200:203], v[116:119], v[148:151], v[200:203]
    v_mfma_f32_16x16x32_bf16 v[200:203], v[120:123], v[144:147], v[200:203]
    v_mfma_f32_16x16x32_bf16 v[204:207], v[112:115], v[156:159], v[204:207]
    v_mfma_f32_16x16x32_bf16 v[204:207], v[116:119], v[152:155], v[204:207]
    v_mfma_f32_16x16x32_bf16 v[204:207], v[120:123], v[148:151], v[204:207]
    v_mfma_f32_16x16x32_bf16 v[204:207], v[124:127], v[144:147], v[204:207]
    v_mfma_f32_16x16x32_bf16 v[208:211], v[112:115], v[160:163], v[208:211]
    v_mfma_f32_16x16x32_bf16 v[208:211], v[116:119], v[156:159], v[208:211]
    v_mfma_f32_16x16x32_bf16 v[208:211], v[120:123], v[152:155], v[208:211]
    v_mfma_f32_16x16x32_bf16 v[208:211], v[124:127], v[148:151], v[208:211]
    v_mfma_f32_16x16x32_bf16 v[208:211], v[128:131], v[144:147], v[208:211]
    v_mfma_f32_16x16x32_bf16 v[212:215], v[112:115], v[164:167], v[212:215]
    v_mfma_f32_16x16x32_bf16 v[212:215], v[116:119], v[160:163], v[212:215]
    v_mfma_f32_16x16x32_bf16 v[212:215], v[120:123], v[156:159], v[212:215]
    v_cvt_pk_bf16_f32 v48, v192, v193
    v_mfma_f32_16x16x32_bf16 v[212:215], v[124:127], v[152:155], v[212:215]
    v_cvt_pk_bf16_f32 v49, v194, v195
    v_mfma_f32_16x16x32_bf16 v[212:215], v[128:131], v[148:151], v[212:215]
    v_cvt_pk_bf16_f32 v50, v196, v197
    v_mfma_f32_16x16x32_bf16 v[212:215], v[132:135], v[144:147], v[212:215]
    v_cvt_pk_bf16_f32 v51, v198, v199
    v_mfma_f32_16x16x32_bf16 v[216:219], v[112:115], v[168:171], v[216:219]
    buffer_store_dwordx4 v[48:51], v18, s[12:15], s43 offen offset:0 nt
    v_mfma_f32_16x16x32_bf16 v[216:219], v[116:119], v[164:167], v[216:219]
    v_cvt_pk_bf16_f32 v52, v200, v201
    v_mfma_f32_16x16x32_bf16 v[216:219], v[120:123], v[160:163], v[216:219]
    v_cvt_pk_bf16_f32 v53, v202, v203
    v_mfma_f32_16x16x32_bf16 v[216:219], v[124:127], v[156:159], v[216:219]
    v_cvt_pk_bf16_f32 v54, v204, v205
    v_mfma_f32_16x16x32_bf16 v[216:219], v[128:131], v[152:155], v[216:219]
    v_cvt_pk_bf16_f32 v55, v206, v207
    v_mfma_f32_16x16x32_bf16 v[216:219], v[132:135], v[148:151], v[216:219]
    buffer_store_dwordx4 v[52:55], v18, s[12:15], s43 offen offset:1024 nt
    v_mfma_f32_16x16x32_bf16 v[216:219], v[136:139], v[144:147], v[216:219]
    v_mfma_f32_16x16x32_bf16 v[220:223], v[112:115], v[172:175], v[220:223]
    ds_write_b32 v24, v25 offset:12
    v_mfma_f32_16x16x32_bf16 v[220:223], v[116:119], v[168:171], v[220:223]
    v_cvt_pk_bf16_f32 v56, v208, v209
    v_mfma_f32_16x16x32_bf16 v[220:223], v[120:123], v[164:167], v[220:223]
    v_cvt_pk_bf16_f32 v57, v210, v211
    v_mfma_f32_16x16x32_bf16 v[220:223], v[124:127], v[160:163], v[220:223]
    v_cvt_pk_bf16_f32 v58, v212, v213
    v_mfma_f32_16x16x32_bf16 v[220:223], v[128:131], v[156:159], v[220:223]
    v_cvt_pk_bf16_f32 v59, v214, v215
    v_mfma_f32_16x16x32_bf16 v[220:223], v[132:135], v[152:155], v[220:223]
    buffer_store_dwordx4 v[56:59], v18, s[12:15], s43 offen offset:2048 nt
    v_mfma_f32_16x16x32_bf16 v[220:223], v[136:139], v[148:151], v[220:223]
    v_mfma_f32_16x16x32_bf16 v[220:223], v[140:143], v[144:147], v[220:223]
    v_cvt_pk_bf16_f32 v60, v216, v217
    v_cvt_pk_bf16_f32 v61, v218, v219
    s_nop 5
    v_cvt_pk_bf16_f32 v62, v220, v221
    v_cvt_pk_bf16_f32 v63, v222, v223
    buffer_store_dwordx4 v[60:63], v18, s[12:15], s43 offen offset:3072 nt
    s_waitcnt vmcnt(4)
    v_lshlrev_b32 v28, 16, v176
    v_and_b32 v29, s35, v176
    v_lshlrev_b32 v30, 16, v177
    v_and_b32 v31, s35, v177
    v_lshlrev_b32 v32, 16, v178
    v_and_b32 v33, s35, v178
    v_lshlrev_b32 v34, 16, v179
    v_and_b32 v35, s35, v179
    v_lshlrev_b32 v36, 16, v180
    v_and_b32 v37, s35, v180
    v_lshlrev_b32 v38, 16, v181
    v_and_b32 v39, s35, v181
    v_lshlrev_b32 v40, 16, v182
    v_and_b32 v41, s35, v182
    v_lshlrev_b32 v42, 16, v183
    v_and_b32 v43, s35, v183
    s_branch B_poll
B_lastrare:
    s_cmp_lg_u32 s48, 0
    s_cbranch_scc1 B_lastslow
    s_mov_b32 s62, 320000
WL_1:
    ds_read_b32 v4, v24 offset:8
    s_sub_u32 s62, s62, 1
    s_cbranch_scc1 WD_2
    s_waitcnt lgkmcnt(0)
    v_cmp_eq_u32 vcc, 0, v4
    s_cbranch_vccnz WL_1
WD_2:
    s_branch B_last2
B_lastslow:
    v_mfma_f32_16x16x32_bf16 v[192:195], v[112:115], v[144:147], v[192:195]
    v_mfma_f32_16x16x32_bf16 v[196:199], v[112:115], v[148:151], v[196:199]
    v_mfma_f32_16x16x32_bf16 v[196:199], v[116:119], v[144:147], v[196:199]
    v_mfma_f32_16x16x32_bf16 v[200:203], v[112:115], v[152:155], v[200:203]
    v_mfma_f32_16x16x32_bf16 v[200:203], v[116:119], v[148:151], v[200:203]
    v_mfma_f32_16x16x32_bf16 v[200:203], v[120:123], v[144:147], v[200:203]
    v_mfma_f32_16x16x32_bf16 v[204:207], v[112:115], v[156:159], v[204:207]
    v_mfma_f32_16x16x32_bf16 v[204:207], v[116:119], v[152:155], v[204:207]
    v_mfma_f32_16x16x32_bf16 v[204:207], v[120:123], v[148:151], v[204:207]
    v_mfma_f32_16x16x32_bf16 v[204:207], v[124:127], v[144:147], v[204:207]
    v_mfma_f32_16x16x32_bf16 v[208:211], v[112:115], v[160:163], v[208:211]
    v_mfma_f32_16x16x32_bf16 v[208:211], v[116:119], v[156:159], v[208:211]
    v_mfma_f32_16x16x32_bf16 v[208:211], v[120:123], v[152:155], v[208:211]
    v_mfma_f32_16x16x32_bf16 v[208:211], v[124:127], v[148:151], v[208:211]
    v_mfma_f32_16x16x32_bf16 v[208:211], v[128:131], v[144:147], v[208:211]
    v_mfma_f32_16x16x32_bf16 v[212:215], v[112:115], v[164:167], v[212:215]
    v_mfma_f32_16x16x32_bf16 v[212:215], v[116:119], v[160:163], v[212:215]
    v_mfma_f32_16x16x32_bf16 v[212:215], v[120:123], v[156:159], v[212:215]
    v_mfma_f32_16x16x32_bf16 v[212:215], v[124:127], v[152:155], v[212:215]
    v_mfma_f32_16x16x32_bf16 v[212:215], v[128:131], v[148:151], v[212:215]
    v_mfma_f32_16x16x32_bf16 v[212:215], v[132:135], v[144:147], v[212:215]
    v_mfma_f32_16x16x32_bf16 v[216:219], v[112:115], v[168:171], v[216:219]
    v_mfma_f32_16x16x32_bf16 v[216:219], v[116:119], v[164:167], v[216:219]
    v_mfma_f32_16x16x32_bf16 v[216:219], v[120:123], v[160:163], v[216:219]
    v_mfma_f32_16x16x32_bf16 v[216:219], v[124:127], v[156:159], v[216:219]
    v_mfma_f32_16x16x32_bf16 v[216:219], v[128:131], v[152:155], v[216:219]
    v_mfma_f32_16x16x32_bf16 v[216:219], v[132:135], v[148:151], v[216:219]
    v_mfma_f32_16x16x32_bf16 v[216:219], v[136:139], v[144:147], v[216:219]
    v_mfma_f32_16x16x32_bf16 v[220:223], v[112:115], v[172:175], v[220:223]
    v_mfma_f32_16x16x32_bf16 v[220:223], v[116:119], v[168:171], v[220:223]
    v_mfma_f32_16x16x32_bf16 v[220:223], v[120:123], v[164:167], v[220:223]
    v_mfma_f32_16x16x32_bf16 v[220:223], v[124:127], v[160:163], v[220:223]
    v_mfma_f32_16x16x32_bf16 v[220:223], v[128:131], v[156:159], v[220:223]
    v_mfma_f32_16x16x32_bf16 v[220:223], v[132:135], v[152:155], v[220:223]
    v_mfma_f32_16x16x32_bf16 v[220:223], v[136:139], v[148:151], v[220:223]
    v_mfma_f32_16x16x32_bf16 v[220:223], v[140:143], v[144:147], v[220:223]
    s_add_u32 s43, s43, 2621440
    s_waitcnt vmcnt(0)
    v_lshlrev_b32 v28, 16, v176
    v_and_b32 v29, s35, v176
    v_lshlrev_b32 v30, 16, v177
    v_and_b32 v31, s35, v177
    v_lshlrev_b32 v32, 16, v178
    v_and_b32 v33, s35, v178
    v_lshlrev_b32 v34, 16, v179
    v_and_b32 v35, s35, v179
    v_lshlrev_b32 v36, 16, v180
    v_and_b32 v37, s35, v180
    v_lshlrev_b32 v38, 16, v181
    v_and_b32 v39, s35, v181
    v_lshlrev_b32 v40, 16, v182
    v_and_b32 v41, s35, v182
    v_lshlrev_b32 v42, 16, v183
    v_and_b32 v43, s35, v183
    v_cvt_pk_bf16_f32 v48, v192, v193
    v_cvt_pk_bf16_f32 v49, v194, v195
    v_cvt_pk_bf16_f32 v50, v196, v197
    v_cvt_pk_bf16_f32 v51, v198, v199
    buffer_store_dwordx4 v[48:51], v18, s[12:15], s43 offen offset:0 sc1
    v_cvt_pk_bf16_f32 v52, v200, v201
    v_cvt_pk_bf16_f32 v53, v202, v203
    v_cvt_pk_bf16_f32 v54, v204, v205
    v_cvt_pk_bf16_f32 v55, v206, v207
    buffer_store_dwordx4 v[52:55], v18, s[12:15], s43 offen offset:1024 sc1
    v_cvt_pk_bf16_f32 v56, v208, v209
    v_cvt_pk_bf16_f32 v57, v210, v211
    v_cvt_pk_bf16_f32 v58, v212, v213
    v_cvt_pk_bf16_f32 v59, v214, v215
    buffer_store_dwordx4 v[56:59], v18, s[12:15], s43 offen offset:2048 sc1
    v_cvt_pk_bf16_f32 v60, v216, v217
    v_cvt_pk_bf16_f32 v61, v218, v219
    v_cvt_pk_bf16_f32 v62, v220, v221
    v_cvt_pk_bf16_f32 v63, v222, v223
    buffer_store_dwordx4 v[60:63], v18, s[12:15], s43 offen offset:3072 sc1
    s_branch B_slow2
B_help:
    s_cmp_lg_u32 s3, 4
    s_cbranch_scc1 B_h5
    s_waitcnt lgkmcnt(0)
    s_mov_b32 s62, 40000
NL_3:
    s_cmp_lg_u32 s60, 0
    s_cbranch_scc1 ND_4
    s_sub_u32 s62, s62, 1
    s_cbranch_scc1 ND_4
    s_sleep 8
    buffer_load_dword v4, v24, s[20:23], 0 offen sc1
    s_waitcnt vmcnt(0)
    v_readfirstlane_b32 s60, v4
    s_branch NL_3
ND_4:
    s_getreg_b32 s32, hwreg(HW_REG_XCC_ID)
    s_and_b32 s32, s32, 15
    s_add_u32 s32, s32, 1
    s_lshl_b32 s32, s32, 1
    s_xor_b32 s32, s32, s60
    v_mov_b32 v9, s32
    s_lshl_b32 s63, s29, 2
    s_add_u32 s63, s63, s34
    v_mov_b32 v10, s60
    v_and_b32 v11, 16, v1
    v_cmp_eq_u32 vcc, 0, v11
    v_lshlrev_b32 v11, 3, v11
    v_lshl_add_u32 v11, v2, 2, v11
    v_cndmask_b32 v10, v10, v9, vcc
    s_waitcnt vmcnt(0)
    s_barrier
    s_mov_b64 exec, 1
    buffer_store_dword v9, v24, s[12:15], s63 offen offset:0
    s_mov_b64 exec, -1
    s_mov_b32 s62, 0
    s_branch XS_6
XC_8:
    buffer_load_dwordx4 v[32:35], v23, s[12:15], s38 offen sc1
    s_add_u32 s33, s38, 8388608
    s_waitcnt vmcnt(0)
    buffer_store_dwordx4 v[32:35], v23, s[12:15], s33 offen sc1
    s_add_u32 s38, s38, 16384
    s_add_u32 s32, s32, 1
    s_cmp_lt_u32 s32, 16
    s_waitcnt vmcnt(0)
    s_cbranch_scc1 XC_8
    v_mov_b32 v4, s60
    s_mov_b64 exec, 1
    buffer_store_dword v4, v24, s[12:15], s63 offen offset:128 sc1
    s_mov_b64 exec, -1
XL_5:
    s_sleep 4
XS_6:
    buffer_load_dword v4, v11, s[12:15], s34 offen offset:0 sc1
    s_add_u32 s62, s62, 1
    s_mov_b32 s33, 0
    s_waitcnt vmcnt(0)
    v_cmp_ne_u32 vcc, v4, v10
    s_nop 0
    s_and_b32 s32, vcc_lo, 0xffff
    s_cbranch_scc0 XD_7
    s_mov_b32 s33, 8388608
    s_lshr_b32 s32, vcc_lo, 16
    s_cbranch_scc0 XD_7
    s_mov_b32 s32, 0
    s_cmp_eq_u32 s62, 24
    s_cbranch_scc1 XC_8
    s_cmp_lt_u32 s62, 40000
    s_cbranch_scc1 XL_5
XD_7:
    v_mov_b32 v4, s33
    ds_write_b32 v24, v4
    s_waitcnt lgkmcnt(0)
    s_branch B_h6
B_h5:
    s_waitcnt vmcnt(0)
    s_barrier
B_h6:
    s_barrier
    ds_read_b32 v4, v24
    s_lshl_b32 s38, s30, 18
    s_lshl_b32 s39, s29, 8
    s_add_u32 s38, s38, s39
    s_lshl_b32 s39, s3, 15
    s_add_u32 s38, s38, s39
    s_mul_i32 s39, s3, 2080
    s_add_u32 s39, s39, 85056
    v_add_u32 v19, s39, v14
    s_waitcnt lgkmcnt(0)
    v_readfirstlane_b32 s48, v4
    v_and_b32 v5, 3, v1
    v_lshlrev_b32 v5, 2, v5
    s_mov_b32 s62, 320000
WL_9:
    s_sleep 1
    ds_read_b32 v4, v5 offset:16
    s_sub_u32 s62, s62, 1
    s_cbranch_scc1 WD_10
    s_waitcnt lgkmcnt(0)
    v_cmp_eq_u32 vcc, 0, v4
    s_cbranch_vccnz WL_9
WD_10:
    buffer_load_dwordx4 v[176:179], v21, s[24:27], s45 offen offset:0 nt
    buffer_load_dwordx4 v[180:183], v21, s[24:27], s45 offen offset:1280 nt
    s_cmp_lg_u32 s48, 0
    s_cbranch_scc1 B_h7
    s_cmp_lg_u32 s3, 4
    s_cbranch_scc1 B_h7
    v_mov_b32 v56, -1
    v_mov_b32 v57, -1
    v_mov_b32 v58, -1
    v_mov_b32 v59, -1
    s_mov_b32 s32, s36
    buffer_store_dwordx4 v[56:59], v14, s[12:15], s32 offen offset:0
    buffer_store_dwordx4 v[56:59], v14, s[12:15], s32 offen offset:1024
    buffer_store_dwordx4 v[56:59], v14, s[12:15], s32 offen offset:2048
    buffer_store_dwordx4 v[56:59], v14, s[12:15], s32 offen offset:3072
    s_add_u32 s32, s32, 4096
    buffer_store_dwordx4 v[56:59], v14, s[12:15], s32 offen offset:0
    buffer_store_dwordx4 v[56:59], v14, s[12:15], s32 offen offset:1024
    buffer_store_dwordx4 v[56:59], v14, s[12:15], s32 offen offset:2048
    buffer_store_dwordx4 v[56:59], v14, s[12:15], s32 offen offset:3072
    s_add_u32 s32, s32, 4096
    buffer_store_dwordx4 v[56:59], v14, s[12:15], s32 offen offset:0
    buffer_store_dwordx4 v[56:59], v14, s[12:15], s32 offen offset:1024
    buffer_store_dwordx4 v[56:59], v14, s[12:15], s32 offen offset:2048
    buffer_store_dwordx4 v[56:59], v14, s[12:15], s32 offen offset:3072
    s_add_u32 s32, s32, 4096
    buffer_store_dwordx4 v[56:59], v14, s[12:15], s32 offen offset:0
    buffer_store_dwordx4 v[56:59], v14, s[12:15], s32 offen offset:1024
    buffer_store_dwordx4 v[56:59], v14, s[12:15], s32 offen offset:2048
    buffer_store_dwordx4 v[56:59], v14, s[12:15], s32 offen offset:3072
    s_waitcnt vmcnt(0)
    s_mov_b64 exec, 1
    buffer_store_dword v9, v24, s[12:15], s63 offen offset:256
    s_mov_b64 exec, 0xffff
    s_mov_b32 s62, 40000
B_cl:
    s_sleep 4
    buffer_load_dword v4, v11, s[12:15], s34 offen offset:256 sc1
    s_sub_u32 s62, s62, 1
    s_cbranch_scc1 B_cd
    s_waitcnt vmcnt(0)
    v_cmp_ne_u32 vcc, v4, v10
    s_cbranch_vccnz B_cl
B_cd:
    s_mov_b64 exec, -1
    v_mov_b32 v4, 1
    ds_write_b32 v24, v4 offset:8
B_h7:
    s_waitcnt vmcnt(0)
    v_lshlrev_b32 v28, 16, v176
    v_and_b32 v29, s35, v176
    v_lshlrev_b32 v30, 16, v177
    v_and_b32 v31, s35, v177
    v_lshlrev_b32 v32, 16, v178
    v_and_b32 v33, s35, v178
    v_lshlrev_b32 v34, 16, v179
    v_and_b32 v35, s35, v179
    v_lshlrev_b32 v36, 16, v180
    v_and_b32 v37, s35, v180
    v_lshlrev_b32 v38, 16, v181
    v_and_b32 v39, s35, v181
    v_lshlrev_b32 v40, 16, v182
    v_and_b32 v41, s35, v182
    v_lshlrev_b32 v42, 16, v183
    v_and_b32 v43, s35, v183
    s_cmp_lg_u32 s48, 0
    s_cbranch_scc1 B_slow2
    s_mov_b32 s62, 320000
WL_11:
    s_sleep 2
    ds_read_b32 v4, v24 offset:12
    s_sub_u32 s62, s62, 1
    s_cbranch_scc1 WD_12
    s_waitcnt lgkmcnt(0)
    v_cmp_eq_u32 vcc, 0, v4
    s_cbranch_vccnz WL_11
WD_12:
    s_branch B_poll
B_slow2:
    s_add_u32 s38, s38, 2621440
    s_waitcnt vmcnt(0)
    s_barrier
    s_cmp_lg_u32 s3, 4
    s_cbranch_scc1 B_s3
    v_mov_b32 v4, s60
    s_mov_b64 exec, 1
    buffer_store_dword v4, v24, s[12:15], s63 offen offset:384 sc1
    s_mov_b64 exec, -1
    v_lshlrev_b32 v5, 2, v2
    s_mov_b32 s62, 40000
    s_branch PS_15
PL_13:
    s_sleep 4
PS_15:
    buffer_load_dword v4, v5, s[12:15], s34 offen offset:384 sc1
    s_sub_u32 s62, s62, 1
    s_cbranch_scc1 PD_14
    s_waitcnt vmcnt(0)
    v_cmp_ne_u32 vcc, s60, v4
    s_cbranch_vccnz PL_13
PD_14:
B_s3:
    s_barrier
B_poll:
    s_add_u32 s46, s38, 16384
    s_cmp_eq_u32 s48, 0
    s_cselect_b32 s62, 40000, 0
B_pl:
    buffer_load_dwordx4 v[64:67], v23, s[12:15], s38 offen sc1
    buffer_load_dwordx4 v[68:71], v23, s[12:15], s46 offen sc1
    s_sub_u32 s62, s62, 1
    s_waitcnt vmcnt(1)
    v_max3_u32 v4, v64, v65, v66
    s_waitcnt vmcnt(0)
    s_cbranch_scc1 B_pd
    v_max3_u32 v4, v4, v67, v68
    v_max3_u32 v5, v69, v70, v71
    v_max_u32 v4, v4, v5
    v_cmp_eq_u32 vcc, -1, v4
    s_cbranch_vccnz B_pl
B_pd:
    ds_write_b128 v19, v[64:67]
    ds_write_b128 v19, v[68:71] offset:1040
    s_waitcnt lgkmcnt(0)
    s_barrier
    ds_read_b32 v72, v20 offset:0
    ds_read_b32 v73, v20 offset:256
    ds_read_b32 v74, v20 offset:512
    ds_read_b32 v75, v20 offset:768
    ds_read_b32 v76, v20 offset:1040
    ds_read_b32 v77, v20 offset:1296
    ds_read_b32 v78, v20 offset:1552
    ds_read_b32 v79, v20 offset:1808
    s_waitcnt lgkmcnt(6)
    v_lshlrev_b32 v80, 16, v72
    v_mul_f32 v80, v80, v28
    v_lshlrev_b32 v81, 16, v73
    v_mul_f32 v81, v81, v29
    s_waitcnt lgkmcnt(4)
    v_lshlrev_b32 v82, 16, v74
    v_mul_f32 v82, v82, v30
    v_lshlrev_b32 v83, 16, v75
    v_mul_f32 v83, v83, v31
    s_waitcnt lgkmcnt(2)
    v_lshlrev_b32 v84, 16, v76
    v_mul_f32 v84, v84, v32
    v_lshlrev_b32 v85, 16, v77
    v_mul_f32 v85, v85, v33
    s_waitcnt lgkmcnt(0)
    v_lshlrev_b32 v86, 16, v78
    v_mul_f32 v86, v86, v34
    v_lshlrev_b32 v87, 16, v79
    v_mul_f32 v87, v87, v35
    v_cvt_pk_bf16_f32 v100, v80, v81
    v_cvt_pk_bf16_f32 v101, v82, v83
    v_cvt_pk_bf16_f32 v102, v84, v85
    v_cvt_pk_bf16_f32 v103, v86, v87
    buffer_store_dwordx4 v[100:103], v22, s[16:19], s47 offen sc1
    v_and_b32 v88, s35, v72
    v_mul_f32 v88, v88, v36
    v_and_b32 v89, s35, v73
    v_mul_f32 v89, v89, v37
    v_and_b32 v90, s35, v74
    v_mul_f32 v90, v90, v38
    v_and_b32 v91, s35, v75
    v_mul_f32 v91, v91, v39
    v_and_b32 v92, s35, v76
    v_mul_f32 v92, v92, v40
    v_and_b32 v93, s35, v77
    v_mul_f32 v93, v93, v41
    v_and_b32 v94, s35, v78
    v_mul_f32 v94, v94, v42
    v_and_b32 v95, s35, v79
    v_mul_f32 v95, v95, v43
    v_cvt_pk_bf16_f32 v104, v88, v89
    v_cvt_pk_bf16_f32 v105, v90, v91
    v_cvt_pk_bf16_f32 v106, v92, v93
    v_cvt_pk_bf16_f32 v107, v94, v95
    buffer_store_dwordx4 v[104:107], v22, s[16:19], s47 offen offset:2560 sc1
    s_endpgm
K_a:
    v_and_b32 v2, 15, v1
    v_lshrrev_b32 v3, 4, v1
    v_mov_b32 v83, 0
    v_mov_b32 v79, 0
    s_cmp_lt_u32 s28, 64
    s_cbranch_scc1 A1_go
    s_waitcnt lgkmcnt(0)
    s_mov_b32 s12, s6
    s_and_b32 s13, s7, 0xffff
    s_mov_b32 s14, 0x1000000
    s_mov_b32 s15, 0x00020000
    s_mov_b32 s16, s8
    s_and_b32 s17, s9, 0xffff
    s_mov_b32 s18, 0x500000
    s_mov_b32 s19, 0x00020000
    s_mov_b32 s20, s10
    s_and_b32 s21, s11, 0xffff
    s_mov_b32 s22, 0x100
    s_mov_b32 s23, 0x00020000
    s_branch A1_done
A1_go:
    s_sub_u32 s29, 128, s28
    s_cmp_eq_u32 s28, 0
    s_cselect_b32 s29, 64, s29
    s_cmp_lt_u32 s3, 4
    s_cselect_b32 s32, s28, s29
    s_and_b32 s30, s3, 3
    s_lshl_b32 s30, s30, 9
    s_add_u32 s30, s30, s32
    s_mul_i32 s30, s30, 1280
    s_mul_i32 s31, s3, 6944
    v_mul_u32_u24 v4, 163840, v3
    v_lshl_add_u32 v4, v2, 4, v4
    s_mov_b32 m0, s31
    s_waitcnt lgkmcnt(0)
    s_mov_b32 s24, s4
    s_and_b32 s25, s5, 0xffff
    s_mov_b32 s26, 0x280000
    s_mov_b32 s27, 0x00020000
    buffer_load_dwordx4 v4, s[24:27], s30 offen offset:0 nt lds
    s_add_u32 m0, m0, 800
    s_nop 0
    buffer_load_dwordx4 v4, s[24:27], s30 offen offset:256 nt lds
    s_add_u32 m0, m0, 800
    s_nop 0
    buffer_load_dwordx4 v4, s[24:27], s30 offen offset:512 nt lds
    s_add_u32 m0, m0, 800
    s_nop 0
    buffer_load_dwordx4 v4, s[24:27], s30 offen offset:768 nt lds
    s_add_u32 m0, m0, 800
    s_nop 0
    buffer_load_dwordx4 v4, s[24:27], s30 offen offset:1024 nt lds
    s_mov_b32 s12, s6
    s_and_b32 s13, s7, 0xffff
    s_mov_b32 s14, 0x1000000
    s_mov_b32 s15, 0x00020000
    s_mov_b32 s16, s8
    s_and_b32 s17, s9, 0xffff
    s_mov_b32 s18, 0x500000
    s_mov_b32 s19, 0x00020000
    s_mov_b32 s20, s10
    s_and_b32 s21, s11, 0xffff
    s_mov_b32 s22, 0x100
    s_mov_b32 s23, 0x00020000
    v_lshrrev_b32 v5, 2, v2
    v_and_b32 v6, 3, v2
    v_lshl_add_u32 v5, v6, 2, v5
    v_cvt_f32_u32 v5, v5
    v_lshlrev_b32 v6, 2, v3
    v_cvt_f32_u32 v6, v6
    v_mul_f32 v80, 0x3d4ccccd, v5
    v_cvt_f32_u32 v81, v3
    v_add_f32 v7, 0x00000000, v6
    v_mul_f32 v7, v7, v80
    v_cos_f32 v84, v7
    v_sin_f32 v92, v7
    v_add_f32 v7, 0x3f800000, v6
    v_mul_f32 v7, v7, v80
    v_cos_f32 v85, v7
    v_sin_f32 v93, v7
    v_add_f32 v7, 0x40000000, v6
    v_mul_f32 v7, v7, v80
    v_cos_f32 v86, v7
    v_sin_f32 v94, v7
    v_add_f32 v7, 0x40400000, v6
    v_mul_f32 v7, v7, v80
    v_cos_f32 v87, v7
    v_sin_f32 v95, v7
    v_add_f32 v7, 0x41800000, v81
    v_mul_f32 v7, v7, v80
    v_cos_f32 v88, v7
    v_sin_f32 v96, v7
    v_mov_b32 v11, 0
    v_mov_b32 v15, 0
    v_cvt_pk_bf16_f32 v8, v84, v85
    v_cvt_pk_bf16_f32 v9, v86, v87
    v_cvt_pk_bf16_f32 v10, v88, 0
    v_cvt_pk_bf16_f32 v12, -v92, -v93
    v_cvt_pk_bf16_f32 v13, -v94, -v95
    v_cvt_pk_bf16_f32 v14, -v96, 0
    v_mul_f32 v5, 0x3acccccd, v5
    v_add_f32 v7, 0x00000000, v6
    v_mul_f32 v7, v7, v5
    v_cos_f32 v40, v7
    v_sin_f32 v48, v7
    v_add_f32 v7, 0x3f800000, v6
    v_mul_f32 v7, v7, v5
    v_cos_f32 v41, v7
    v_sin_f32 v49, v7
    v_add_f32 v7, 0x40000000, v6
    v_mul_f32 v7, v7, v5
    v_cos_f32 v42, v7
    v_sin_f32 v50, v7
    v_add_f32 v7, 0x40400000, v6
    v_mul_f32 v7, v7, v5
    v_cos_f32 v43, v7
    v_sin_f32 v51, v7
    v_add_f32 v7, 0x41800000, v6
    v_mul_f32 v7, v7, v5
    v_cos_f32 v44, v7
    v_sin_f32 v52, v7
    v_add_f32 v7, 0x41880000, v6
    v_mul_f32 v7, v7, v5
    v_cos_f32 v45, v7
    v_sin_f32 v53, v7
    v_add_f32 v7, 0x41900000, v6
    v_mul_f32 v7, v7, v5
    v_cos_f32 v46, v7
    v_sin_f32 v54, v7
    v_add_f32 v7, 0x41980000, v6
    v_mul_f32 v7, v7, v5
    v_cos_f32 v47, v7
    v_sin_f32 v55, v7
    v_cvt_f32_u32 v82, v2
    v_mul_f32 v80, 0x3d000000, v82
    v_and_b32 v81, 1, v2
    s_mov_b32 s38, 0x80008000
    v_mul_lo_u32 v81, v81, s38
    v_add_f32 v7, 0x00000000, v6
    v_mul_f32 v7, v7, v80
    v_cos_f32 v84, v7
    v_sin_f32 v92, v7
    v_add_f32 v7, 0x3f800000, v6
    v_mul_f32 v7, v7, v80
    v_cos_f32 v85, v7
    v_sin_f32 v93, v7
    v_add_f32 v7, 0x40000000, v6
    v_mul_f32 v7, v7, v80
    v_cos_f32 v86, v7
    v_sin_f32 v94, v7
    v_add_f32 v7, 0x40400000, v6
    v_mul_f32 v7, v7, v80
    v_cos_f32 v87, v7
    v_sin_f32 v95, v7
    s_mov_b32 s39, 0x80000000
    s_mov_b32 s40, 0x00008000
    v_cvt_pk_bf16_f32 v16, v84, v85
    v_cvt_pk_bf16_f32 v17, v86, v87
    v_xor_b32 v18, v81, v16
    v_xor_b32 v19, v81, v17
    v_cvt_pk_bf16_f32 v20, v92, v93
    v_cvt_pk_bf16_f32 v21, v94, v95
    v_xor_b32 v22, v81, v20
    v_xor_b32 v23, v81, v21
    v_xor_b32 v24, s38, v20
    v_xor_b32 v28, s39, v16
    v_xor_b32 v32, s39, v20
    v_xor_b32 v36, s40, v16
    v_xor_b32 v25, s38, v21
    v_xor_b32 v29, s39, v17
    v_xor_b32 v33, s39, v21
    v_xor_b32 v37, s40, v17
    v_xor_b32 v26, s38, v22
    v_xor_b32 v30, s39, v18
    v_xor_b32 v34, s39, v22
    v_xor_b32 v38, s40, v18
    v_xor_b32 v27, s38, v23
    v_xor_b32 v31, s39, v19
    v_xor_b32 v35, s39, v23
    v_xor_b32 v39, s40, v19
    v_mul_u32_u24 v5, 1056, v3
    v_lshrrev_b32 v6, 2, v2
    v_and_b32 v7, 3, v2
    v_lshl_add_u32 v5, v6, 6, v5
    v_lshl_add_u32 v5, v7, 3, v5
    v_add_u32 v76, s31, v5
    v_lshlrev_b32 v5, 6, v3
    v_lshl_add_u32 v5, v7, 3, v5
    v_add_u32 v5, 4224, v5
    v_add_u32 v77, s31, v5
    v_mul_u32_u24 v5, 576, v3
    v_lshl_add_u32 v5, v2, 4, v5
    v_add_u32 v78, s31, v5
    s_cmp_ge_u32 s3, 6
    s_cbranch_scc1 A1_no3
    v_mul_f32 v5, 0x3a000000, v82
    v_lshlrev_b32 v79, 9, v3
    v_add_u32 v80, s28, v79
    v_cvt_f32_u32 v80, v80
    v_add_f32 v81, 0x00000000, v80
    v_mul_f32 v81, v81, v5
    v_cos_f32 v84, v81
    v_sin_f32 v92, v81
    v_add_f32 v81, 0x43000000, v80
    v_mul_f32 v81, v81, v5
    v_cos_f32 v85, v81
    v_sin_f32 v93, v81
    v_add_f32 v81, 0x43800000, v80
    v_mul_f32 v81, v81, v5
    v_cos_f32 v86, v81
    v_sin_f32 v94, v81
    v_add_f32 v81, 0x43c00000, v80
    v_mul_f32 v81, v81, v5
    v_cos_f32 v87, v81
    v_sin_f32 v95, v81
    v_cvt_pk_bf16_f32 v56, v84, v92
    v_cvt_pk_bf16_f32 v64, -v92, v84
    v_cvt_pk_bf16_f32 v57, v85, v93
    v_cvt_pk_bf16_f32 v65, -v93, v85
    v_cvt_pk_bf16_f32 v58, v86, v94
    v_cvt_pk_bf16_f32 v66, -v94, v86
    v_cvt_pk_bf16_f32 v59, v87, v95
    v_cvt_pk_bf16_f32 v67, -v95, v87
    v_add_u32 v80, s29, v79
    v_cvt_f32_u32 v80, v80
    v_add_f32 v81, 0x00000000, v80
    v_mul_f32 v81, v81, v5
    v_cos_f32 v84, v81
    v_sin_f32 v92, v81
    v_add_f32 v81, 0x43000000, v80
    v_mul_f32 v81, v81, v5
    v_cos_f32 v85, v81
    v_sin_f32 v93, v81
    v_add_f32 v81, 0x43800000, v80
    v_mul_f32 v81, v81, v5
    v_cos_f32 v86, v81
    v_sin_f32 v94, v81
    v_add_f32 v81, 0x43c00000, v80
    v_mul_f32 v81, v81, v5
    v_cos_f32 v87, v81
    v_sin_f32 v95, v81
    v_cvt_pk_bf16_f32 v60, v84, v92
    v_cvt_pk_bf16_f32 v68, v92, -v84
    v_cvt_pk_bf16_f32 v61, v85, v93
    v_cvt_pk_bf16_f32 v69, v93, -v85
    v_cvt_pk_bf16_f32 v62, v86, v94
    v_cvt_pk_bf16_f32 v70, v94, -v86
    v_cvt_pk_bf16_f32 v63, v87, v95
    v_cvt_pk_bf16_f32 v71, v95, -v87
    s_cmp_lg_u32 s28, 0
    s_cbranch_scc1 A1_nog0
    v_mov_b32 v68, v60
    v_mov_b32 v60, 0
    v_mov_b32 v64, 0
    v_mov_b32 v69, v61
    v_mov_b32 v61, 0
    v_mov_b32 v65, 0
    v_mov_b32 v70, v62
    v_mov_b32 v62, 0
    v_mov_b32 v66, 0
    v_mov_b32 v71, v63
    v_mov_b32 v63, 0
    v_mov_b32 v67, 0
A1_nog0:
    s_lshl_b32 s33, s3, 6
    v_lshl_add_u32 v5, v7, 4, v6
    v_add_u32 v5, s33, v5
    s_cmp_lg_u32 s3, 5
    s_cbranch_scc1 A1_e0
    v_add_u32 v5, 1, v2
    v_min_u32 v5, 5, v5
    v_lshlrev_b32 v5, 6, v5
A1_e0:
    v_mul_u32_u24 v80, 6944, v3
    s_and_b32 s33, s28, 3
    s_lshl_b32 s33, s33, 2
    v_xor_b32 v79, s33, v2
    v_lshlrev_b32 v79, 4, v79
    v_mul_u32_u24 v7, 327680, v3
    v_add_u32 v79, v79, v7
    s_lshl_b32 s34, s28, 8
    s_lshl_b32 s33, s3, 14
    s_add_u32 s34, s34, s33
    s_add_u32 s34, s34, 5242880
    s_add_u32 s35, s34, 81920
    s_add_u32 s36, s35, 81920
    s_add_u32 s37, s36, 81920
    v_mul_u32_u24 v6, 3277, v5
    v_lshrrev_b32 v6, 16, v6
    v_mul_u32_u24 v7, 20, v6
    v_sub_u32 v7, v5, v7
    v_cmp_gt_u32 vcc, 11, v7
    v_mul_u32_u24 v7, 576, v7
    v_lshl_add_u32 v7, v6, 4, v7
    v_sub_u32 v6, 12016, v7
    v_cndmask_b32 v7, v6, v7, vcc
    v_add_u32 v72, v7, v80
    v_add_u32 v5, 4, v5
    v_mul_u32_u24 v6, 3277, v5
    v_lshrrev_b32 v6, 16, v6
    v_mul_u32_u24 v7, 20, v6
    v_sub_u32 v7, v5, v7
    v_cmp_gt_u32 vcc, 11, v7
    v_mul_u32_u24 v7, 576, v7
    v_lshl_add_u32 v7, v6, 4, v7
    v_sub_u32 v6, 12016, v7
    v_cndmask_b32 v7, v6, v7, vcc
    v_add_u32 v73, v7, v80
    v_add_u32 v5, 4, v5
    v_mul_u32_u24 v6, 3277, v5
    v_lshrrev_b32 v6, 16, v6
    v_mul_u32_u24 v7, 20, v6
    v_sub_u32 v7, v5, v7
    v_cmp_gt_u32 vcc, 11, v7
    v_mul_u32_u24 v7, 576, v7
    v_lshl_add_u32 v7, v6, 4, v7
    v_sub_u32 v6, 12016, v7
    v_cndmask_b32 v7, v6, v7, vcc
    v_add_u32 v74, v7, v80
    v_add_u32 v5, 4, v5
    v_mul_u32_u24 v6, 3277, v5
    v_lshrrev_b32 v6, 16, v6
    v_mul_u32_u24 v7, 20, v6
    v_sub_u32 v7, v5, v7
    v_cmp_gt_u32 vcc, 11, v7
    v_mul_u32_u24 v7, 576, v7
    v_lshl_add_u32 v7, v6, 4, v7
    v_sub_u32 v6, 12016, v7
    v_cndmask_b32 v7, v6, v7, vcc
    v_add_u32 v75, v7, v80
A1_no3:
    s_waitcnt vmcnt(0)
    ds_read_b64_tr_b16 v[84:85], v76 offset:0
    ds_read_b64_tr_b16 v[86:87], v77 offset:0
    ds_read_b64_tr_b16 v[88:89], v76 offset:32
    ds_read_b64_tr_b16 v[90:91], v77 offset:32
    ds_read_b64_tr_b16 v[92:93], v76 offset:256
    ds_read_b64_tr_b16 v[94:95], v77 offset:256
    ds_read_b64_tr_b16 v[96:97], v76 offset:288
    ds_read_b64_tr_b16 v[98:99], v77 offset:288
    ds_read_b64_tr_b16 v[100:101], v76 offset:512
    ds_read_b64_tr_b16 v[102:103], v77 offset:512
    ds_read_b64_tr_b16 v[104:105], v76 offset:544
    ds_read_b64_tr_b16 v[106:107], v77 offset:544
    s_waitcnt lgkmcnt(8)
    ds_read_b64_tr_b16 v[108:109], v76 offset:768
    ds_read_b64_tr_b16 v[110:111], v77 offset:768
    ds_read_b64_tr_b16 v[112:113], v76 offset:800
    ds_read_b64_tr_b16 v[114:115], v77 offset:800
    v_mfma_f32_16x16x32_bf16 v[116:119], v[84:87], v[8:11], 0
    v_mfma_f32_16x16x32_bf16 v[120:123], v[84:87], v[12:15], 0
    v_mfma_f32_16x16x32_bf16 v[124:127], v[88:91], v[8:11], 0
    v_mfma_f32_16x16x32_bf16 v[128:131], v[88:91], v[12:15], 0
    s_nop 4
    v_mul_f32 v132, v116, v40
    v_mul_f32 v140, v120, v40
    v_fmac_f32 v132, v120, v48
    v_fma_f32 v140, -v116, v48, v140
    v_mul_f32 v133, v117, v41
    v_mul_f32 v141, v121, v41
    v_fmac_f32 v133, v121, v49
    v_fma_f32 v141, -v117, v49, v141
    v_mul_f32 v134, v118, v42
    v_mul_f32 v142, v122, v42
    v_fmac_f32 v134, v122, v50
    v_fma_f32 v142, -v118, v50, v142
    v_mul_f32 v135, v119, v43
    v_mul_f32 v143, v123, v43
    v_fmac_f32 v135, v123, v51
    v_fma_f32 v143, -v119, v51, v143
    v_mul_f32 v136, v124, v44
    v_mul_f32 v144, v128, v44
    v_fmac_f32 v136, v128, v52
    v_fma_f32 v144, -v124, v52, v144
    v_mul_f32 v137, v125, v45
    v_mul_f32 v145, v129, v45
    v_fmac_f32 v137, v129, v53
    v_fma_f32 v145, -v125, v53, v145
    v_mul_f32 v138, v126, v46
    v_mul_f32 v146, v130, v46
    v_fmac_f32 v138, v130, v54
    v_fma_f32 v146, -v126, v54, v146
    v_mul_f32 v139, v127, v47
    v_mul_f32 v147, v131, v47
    v_fmac_f32 v139, v131, v55
    v_fma_f32 v147, -v127, v55, v147
    v_cvt_pk_bf16_f32 v148, v132, v133
    v_cvt_pk_bf16_f32 v152, v140, v141
    v_cvt_pk_bf16_f32 v149, v134, v135
    v_cvt_pk_bf16_f32 v153, v142, v143
    v_cvt_pk_bf16_f32 v150, v136, v137
    v_cvt_pk_bf16_f32 v154, v144, v145
    v_cvt_pk_bf16_f32 v151, v138, v139
    v_cvt_pk_bf16_f32 v155, v146, v147
    s_nop 0
    v_mfma_f32_16x16x32_bf16 v[156:159], v[148:151], v[16:19], 0
    v_mfma_f32_16x16x32_bf16 v[160:163], v[148:151], v[24:27], 0
    v_mfma_f32_16x16x32_bf16 v[164:167], v[148:151], v[28:31], 0
    v_mfma_f32_16x16x32_bf16 v[168:171], v[148:151], v[32:35], 0
    v_mfma_f32_16x16x32_bf16 v[156:159], v[152:155], v[20:23], v[156:159]
    v_mfma_f32_16x16x32_bf16 v[160:163], v[152:155], v[16:19], v[160:163]
    v_mfma_f32_16x16x32_bf16 v[164:167], v[152:155], v[32:35], v[164:167]
    v_mfma_f32_16x16x32_bf16 v[168:171], v[152:155], v[36:39], v[168:171]
    s_waitcnt lgkmcnt(8)
    v_mfma_f32_16x16x32_bf16 v[116:119], v[92:95], v[8:11], 0
    v_mfma_f32_16x16x32_bf16 v[120:123], v[92:95], v[12:15], 0
    v_mfma_f32_16x16x32_bf16 v[124:127], v[96:99], v[8:11], 0
    v_mfma_f32_16x16x32_bf16 v[128:131], v[96:99], v[12:15], 0
    s_nop 4
    v_mul_f32 v132, v116, v40
    v_mul_f32 v140, v120, v40
    v_fmac_f32 v132, v120, v48
    v_fma_f32 v140, -v116, v48, v140
    v_mul_f32 v133, v117, v41
    v_mul_f32 v141, v121, v41
    v_fmac_f32 v133, v121, v49
    v_fma_f32 v141, -v117, v49, v141
    v_mul_f32 v134, v118, v42
    v_mul_f32 v142, v122, v42
    v_fmac_f32 v134, v122, v50
    v_fma_f32 v142, -v118, v50, v142
    v_mul_f32 v135, v119, v43
    v_mul_f32 v143, v123, v43
    v_fmac_f32 v135, v123, v51
    v_fma_f32 v143, -v119, v51, v143
    v_mul_f32 v136, v124, v44
    v_mul_f32 v144, v128, v44
    v_fmac_f32 v136, v128, v52
    v_fma_f32 v144, -v124, v52, v144
    v_mul_f32 v137, v125, v45
    v_mul_f32 v145, v129, v45
    v_fmac_f32 v137, v129, v53
    v_fma_f32 v145, -v125, v53, v145
    v_mul_f32 v138, v126, v46
    v_mul_f32 v146, v130, v46
    v_fmac_f32 v138, v130, v54
    v_fma_f32 v146, -v126, v54, v146
    v_mul_f32 v139, v127, v47
    v_mul_f32 v147, v131, v47
    v_fmac_f32 v139, v131, v55
    v_fma_f32 v147, -v127, v55, v147
    v_cvt_pk_bf16_f32 v148, v132, v133
    v_cvt_pk_bf16_f32 v152, v140, v141
    v_cvt_pk_bf16_f32 v149, v134, v135
    v_cvt_pk_bf16_f32 v153, v142, v143
    v_cvt_pk_bf16_f32 v150, v136, v137
    v_cvt_pk_bf16_f32 v154, v144, v145
    v_cvt_pk_bf16_f32 v151, v138, v139
    v_cvt_pk_bf16_f32 v155, v146, v147
    s_nop 0
    v_mfma_f32_16x16x32_bf16 v[172:175], v[148:151], v[16:19], 0
    v_mfma_f32_16x16x32_bf16 v[176:179], v[148:151], v[24:27], 0
    v_mfma_f32_16x16x32_bf16 v[180:183], v[148:151], v[28:31], 0
    v_mfma_f32_16x16x32_bf16 v[184:187], v[148:151], v[32:35], 0
    v_mfma_f32_16x16x32_bf16 v[172:175], v[152:155], v[20:23], v[172:175]
    v_mfma_f32_16x16x32_bf16 v[176:179], v[152:155], v[16:19], v[176:179]
    v_mfma_f32_16x16x32_bf16 v[180:183], v[152:155], v[32:35], v[180:183]
    v_mfma_f32_16x16x32_bf16 v[184:187], v[152:155], v[36:39], v[184:187]
    s_waitcnt lgkmcnt(4)
    v_mfma_f32_16x16x32_bf16 v[116:119], v[100:103], v[8:11], 0
    v_mfma_f32_16x16x32_bf16 v[120:123], v[100:103], v[12:15], 0
    v_mfma_f32_16x16x32_bf16 v[124:127], v[104:107], v[8:11], 0
    v_mfma_f32_16x16x32_bf16 v[128:131], v[104:107], v[12:15], 0
    s_nop 4
    v_mul_f32 v132, v116, v40
    v_mul_f32 v140, v120, v40
    v_fmac_f32 v132, v120, v48
    v_fma_f32 v140, -v116, v48, v140
    v_mul_f32 v133, v117, v41
    v_mul_f32 v141, v121, v41
    v_fmac_f32 v133, v121, v49
    v_fma_f32 v141, -v117, v49, v141
    v_mul_f32 v134, v118, v42
    v_mul_f32 v142, v122, v42
    v_fmac_f32 v134, v122, v50
    v_fma_f32 v142, -v118, v50, v142
    v_mul_f32 v135, v119, v43
    v_mul_f32 v143, v123, v43
    v_fmac_f32 v135, v123, v51
    v_fma_f32 v143, -v119, v51, v143
    v_mul_f32 v136, v124, v44
    v_mul_f32 v144, v128, v44
    v_fmac_f32 v136, v128, v52
    v_fma_f32 v144, -v124, v52, v144
    v_mul_f32 v137, v125, v45
    v_mul_f32 v145, v129, v45
    v_fmac_f32 v137, v129, v53
    v_fma_f32 v145, -v125, v53, v145
    v_mul_f32 v138, v126, v46
    v_mul_f32 v146, v130, v46
    v_fmac_f32 v138, v130, v54
    v_fma_f32 v146, -v126, v54, v146
    v_mul_f32 v139, v127, v47
    v_mul_f32 v147, v131, v47
    v_fmac_f32 v139, v131, v55
    v_fma_f32 v147, -v127, v55, v147
    v_cvt_pk_bf16_f32 v148, v132, v133
    v_cvt_pk_bf16_f32 v152, v140, v141
    v_cvt_pk_bf16_f32 v149, v134, v135
    v_cvt_pk_bf16_f32 v153, v142, v143
    v_cvt_pk_bf16_f32 v150, v136, v137
    v_cvt_pk_bf16_f32 v154, v144, v145
    v_cvt_pk_bf16_f32 v151, v138, v139
    v_cvt_pk_bf16_f32 v155, v146, v147
    s_nop 0
    v_mfma_f32_16x16x32_bf16 v[188:191], v[148:151], v[16:19], 0
    v_mfma_f32_16x16x32_bf16 v[192:195], v[148:151], v[24:27], 0
    v_mfma_f32_16x16x32_bf16 v[196:199], v[148:151], v[28:31], 0
    v_mfma_f32_16x16x32_bf16 v[200:203], v[148:151], v[32:35], 0
    v_mfma_f32_16x16x32_bf16 v[188:191], v[152:155], v[20:23], v[188:191]
    v_mfma_f32_16x16x32_bf16 v[192:195], v[152:155], v[16:19], v[192:195]
    v_mfma_f32_16x16x32_bf16 v[196:199], v[152:155], v[32:35], v[196:199]
    v_mfma_f32_16x16x32_bf16 v[200:203], v[152:155], v[36:39], v[200:203]
    s_waitcnt lgkmcnt(0)
    v_mfma_f32_16x16x32_bf16 v[116:119], v[108:111], v[8:11], 0
    v_mfma_f32_16x16x32_bf16 v[120:123], v[108:111], v[12:15], 0
    v_mfma_f32_16x16x32_bf16 v[124:127], v[112:115], v[8:11], 0
    v_mfma_f32_16x16x32_bf16 v[128:131], v[112:115], v[12:15], 0
    s_nop 4
    v_mul_f32 v132, v116, v40
    v_mul_f32 v140, v120, v40
    v_fmac_f32 v132, v120, v48
    v_fma_f32 v140, -v116, v48, v140
    v_mul_f32 v133, v117, v41
    v_mul_f32 v141, v121, v41
    v_fmac_f32 v133, v121, v49
    v_fma_f32 v141, -v117, v49, v141
    v_mul_f32 v134, v118, v42
    v_mul_f32 v142, v122, v42
    v_fmac_f32 v134, v122, v50
    v_fma_f32 v142, -v118, v50, v142
    v_mul_f32 v135, v119, v43
    v_mul_f32 v143, v123, v43
    v_fmac_f32 v135, v123, v51
    v_fma_f32 v143, -v119, v51, v143
    v_mul_f32 v136, v124, v44
    v_mul_f32 v144, v128, v44
    v_fmac_f32 v136, v128, v52
    v_fma_f32 v144, -v124, v52, v144
    v_mul_f32 v137, v125, v45
    v_mul_f32 v145, v129, v45
    v_fmac_f32 v137, v129, v53
    v_fma_f32 v145, -v125, v53, v145
    v_mul_f32 v138, v126, v46
    v_mul_f32 v146, v130, v46
    v_fmac_f32 v138, v130, v54
    v_fma_f32 v146, -v126, v54, v146
    v_mul_f32 v139, v127, v47
    v_mul_f32 v147, v131, v47
    v_fmac_f32 v139, v131, v55
    v_fma_f32 v147, -v127, v55, v147
    v_cvt_pk_bf16_f32 v148, v132, v133
    v_cvt_pk_bf16_f32 v152, v140, v141
    v_cvt_pk_bf16_f32 v149, v134, v135
    v_cvt_pk_bf16_f32 v153, v142, v143
    v_cvt_pk_bf16_f32 v150, v136, v137
    v_cvt_pk_bf16_f32 v154, v144, v145
    v_cvt_pk_bf16_f32 v151, v138, v139
    v_cvt_pk_bf16_f32 v155, v146, v147
    s_nop 0
    v_mfma_f32_16x16x32_bf16 v[204:207], v[148:151], v[16:19], 0
    v_mfma_f32_16x16x32_bf16 v[208:211], v[148:151], v[24:27], 0
    v_mfma_f32_16x16x32_bf16 v[212:215], v[148:151], v[28:31], 0
    v_mfma_f32_16x16x32_bf16 v[216:219], v[148:151], v[32:35], 0
    v_mfma_f32_16x16x32_bf16 v[204:207], v[152:155], v[20:23], v[204:207]
    v_mfma_f32_16x16x32_bf16 v[208:211], v[152:155], v[16:19], v[208:211]
    v_mfma_f32_16x16x32_bf16 v[212:215], v[152:155], v[32:35], v[212:215]
    v_mfma_f32_16x16x32_bf16 v[216:219], v[152:155], v[36:39], v[216:219]
    v_cvt_pk_bf16_f32 v84, v156, v160
    v_cvt_pk_bf16_f32 v85, v172, v176
    v_cvt_pk_bf16_f32 v86, v188, v192
    s_nop 2
    v_cvt_pk_bf16_f32 v87, v204, v208
    ds_write_b128 v78, v[84:87] offset:0
    v_cvt_pk_bf16_f32 v88, v157, v161
    v_cvt_pk_bf16_f32 v89, v173, v177
    v_cvt_pk_bf16_f32 v90, v189, v193
    v_cvt_pk_bf16_f32 v91, v205, v209
    ds_write_b128 v78, v[88:91] offset:2304
    v_cvt_pk_bf16_f32 v92, v158, v162
    v_cvt_pk_bf16_f32 v93, v174, v178
    v_cvt_pk_bf16_f32 v94, v190, v194
    v_cvt_pk_bf16_f32 v95, v206, v210
    ds_write_b128 v78, v[92:95] offset:4608
    v_cvt_pk_bf16_f32 v96, v164, v168
    v_cvt_pk_bf16_f32 v97, v180, v184
    v_cvt_pk_bf16_f32 v98, v196, v200
    v_cvt_pk_bf16_f32 v99, v212, v216
    ds_write_b128 v78, v[96:99] offset:256
    v_cvt_pk_bf16_f32 v100, v165, v169
    v_cvt_pk_bf16_f32 v101, v181, v185
    v_cvt_pk_bf16_f32 v102, v197, v201
    v_cvt_pk_bf16_f32 v103, v213, v217
    ds_write_b128 v78, v[100:103] offset:2560
    v_cvt_pk_bf16_f32 v104, v166, v170
    v_cvt_pk_bf16_f32 v105, v182, v186
    v_cvt_pk_bf16_f32 v106, v198, v202
    v_cvt_pk_bf16_f32 v107, v214, v218
    ds_write_b128 v78, v[104:107] offset:4864
    s_waitcnt lgkmcnt(0)
    s_barrier
    s_cmp_gt_u32 s3, 5
    s_cbranch_scc1 A1_done
    s_cmp_eq_u32 s3, 5
    s_cbranch_scc1 A1_bd
    ds_read_b128 v[116:119], v72 offset:0
    ds_read_b128 v[120:123], v72 offset:27776
    ds_read_b128 v[124:127], v73 offset:0
    ds_read_b128 v[128:131], v73 offset:27776
    ds_read_b128 v[132:135], v74 offset:0
    ds_read_b128 v[136:139], v74 offset:27776
    ds_read_b128 v[140:143], v75 offset:0
    ds_read_b128 v[144:147], v75 offset:27776
    s_waitcnt lgkmcnt(6)
    v_mfma_f32_16x16x32_bf16 v[156:159], v[56:59], v[116:119], 0
    v_mfma_f32_16x16x32_bf16 v[160:163], v[64:67], v[116:119], 0
    v_mfma_f32_16x16x32_bf16 v[156:159], v[60:63], v[120:123], v[156:159]
    v_mfma_f32_16x16x32_bf16 v[160:163], v[68:71], v[120:123], v[160:163]
    s_waitcnt lgkmcnt(4)
    v_mfma_f32_16x16x32_bf16 v[164:167], v[56:59], v[124:127], 0
    v_mfma_f32_16x16x32_bf16 v[168:171], v[64:67], v[124:127], 0
    v_mfma_f32_16x16x32_bf16 v[164:167], v[60:63], v[128:131], v[164:167]
    v_mfma_f32_16x16x32_bf16 v[168:171], v[68:71], v[128:131], v[168:171]
    s_waitcnt lgkmcnt(2)
    v_mfma_f32_16x16x32_bf16 v[172:175], v[56:59], v[132:135], 0
    v_mfma_f32_16x16x32_bf16 v[176:179], v[64:67], v[132:135], 0
    v_mfma_f32_16x16x32_bf16 v[172:175], v[60:63], v[136:139], v[172:175]
    v_mfma_f32_16x16x32_bf16 v[176:179], v[68:71], v[136:139], v[176:179]
    s_waitcnt lgkmcnt(0)
    v_mfma_f32_16x16x32_bf16 v[180:183], v[56:59], v[140:143], 0
    v_mfma_f32_16x16x32_bf16 v[184:187], v[64:67], v[140:143], 0
    v_mfma_f32_16x16x32_bf16 v[180:183], v[60:63], v[144:147], v[180:183]
    v_mfma_f32_16x16x32_bf16 v[184:187], v[68:71], v[144:147], v[184:187]
    v_cvt_pk_bf16_f32 v84, v156, v164
    s_nop 5
    v_cvt_pk_bf16_f32 v85, v172, v180
    v_cvt_pk_bf16_f32 v86, v160, v168
    v_cvt_pk_bf16_f32 v87, v176, v184
    buffer_store_dwordx4 v[84:87], v79, s[12:15], s34 offen sc1
    v_cvt_pk_bf16_f32 v88, v157, v165
    v_cvt_pk_bf16_f32 v89, v173, v181
    v_cvt_pk_bf16_f32 v90, v161, v169
    v_cvt_pk_bf16_f32 v91, v177, v185
    buffer_store_dwordx4 v[88:91], v79, s[12:15], s35 offen sc1
    v_cvt_pk_bf16_f32 v92, v158, v166
    v_cvt_pk_bf16_f32 v93, v174, v182
    v_cvt_pk_bf16_f32 v94, v162, v170
    v_cvt_pk_bf16_f32 v95, v178, v186
    buffer_store_dwordx4 v[92:95], v79, s[12:15], s36 offen sc1
    v_cvt_pk_bf16_f32 v96, v159, v167
    v_cvt_pk_bf16_f32 v97, v175, v183
    v_cvt_pk_bf16_f32 v98, v163, v171
    v_cvt_pk_bf16_f32 v99, v179, v187
    buffer_store_dwordx4 v[96:99], v79, s[12:15], s37 offen sc1
    s_branch A1_done
A1_bd:
    ds_read_b128 v[116:119], v72 offset:0
    ds_read_b128 v[120:123], v72 offset:27776
    v_lshlrev_b32 v79, 4, v1
    s_lshl_b32 s34, s28, 9
    s_add_u32 s34, s34, 6553600
    s_waitcnt lgkmcnt(0)
    v_mfma_f32_16x16x32_bf16 v[156:159], v[116:119], v[56:59], 0
    v_mfma_f32_16x16x32_bf16 v[160:163], v[116:119], v[64:67], 0
    v_mfma_f32_16x16x32_bf16 v[156:159], v[120:123], v[60:63], v[156:159]
    v_mfma_f32_16x16x32_bf16 v[160:163], v[120:123], v[68:71], v[160:163]
    s_nop 7
    v_cvt_pk_bf16_f32 v84, v156, v160
    v_cvt_pk_bf16_f32 v85, v157, v161
    v_cvt_pk_bf16_f32 v86, v158, v162
    v_cvt_pk_bf16_f32 v87, v159, v163
    s_mov_b32 exec_hi, 0
    buffer_store_dwordx4 v[84:87], v79, s[12:15], s34 offen sc1
    s_mov_b64 exec, -1
A1_done:
    s_load_dword s60, s[10:11], 0
    s_mul_i32 s29, s28, 205
    s_lshr_b32 s29, s29, 10
    s_mul_i32 s30, s29, 5
    s_sub_u32 s30, s28, s30
    s_lshl_b32 s35, s3, 4
    v_add_u32 v5, s35, v2
    v_cvt_f32_u32 v6, v5
    v_mul_f32 v6, 0x3c000000, v6
    v_lshrrev_b32 v7, 1, v3
    v_lshlrev_b32 v7, 3, v7
    v_and_b32 v8, 1, v3
    v_lshl_add_u32 v7, v8, 1, v7
    v_cvt_f32_u32 v8, v7
    v_add_f32 v9, 0x00000000, v8
    v_mul_f32 v9, v9, v6
    v_cos_f32 v32, v9
    v_sin_f32 v36, v9
    v_add_f32 v9, 0x3f800000, v8
    v_mul_f32 v9, v9, v6
    v_cos_f32 v33, v9
    v_sin_f32 v37, v9
    v_add_f32 v9, 0x40800000, v8
    v_mul_f32 v9, v9, v6
    v_cos_f32 v34, v9
    v_sin_f32 v38, v9
    v_add_f32 v9, 0x40a00000, v8
    v_mul_f32 v9, v9, v6
    v_cos_f32 v35, v9
    v_sin_f32 v39, v9
    v_cvt_pk_bf16_f32 v16, v32, v36
    v_cvt_pk_bf16_f32 v17, v33, v37
    v_cvt_pk_bf16_f32 v18, v34, v38
    v_cvt_pk_bf16_f32 v19, v35, v39
    s_waitcnt vmcnt(0) lgkmcnt(0)
    s_mov_b32 s44, 6897664
    s_cmp_ge_u32 s28, 64
    s_cbranch_scc1 A_nobar
    s_barrier
A_nobar:
    s_cmp_lg_u32 s3, 7
    s_cbranch_scc1 A_nopost
    s_mov_b32 s62, 40000
NL_16:
    s_cmp_lg_u32 s60, 0
    s_cbranch_scc1 ND_17
    s_sub_u32 s62, s62, 1
    s_cbranch_scc1 ND_17
    s_sleep 8
    buffer_load_dword v4, v83, s[20:23], 0 offen sc1
    s_waitcnt vmcnt(0)
    v_readfirstlane_b32 s60, v4
    s_branch NL_16
ND_17:
    s_cmp_ge_u32 s28, 64
    s_cbranch_scc1 A_nopost
    s_lshl_b32 s36, s28, 7
    s_add_u32 s36, s36, s44
    v_mov_b32 v4, s60
    s_mov_b64 exec, 1
    buffer_store_dword v4, v83, s[12:15], s36 offen offset:0 sc1
    s_mov_b64 exec, -1
A_nopost:
    v_add_f32 v9, 0x41800000, v8
    v_mul_f32 v9, v9, v6
    v_cos_f32 v32, v9
    v_sin_f32 v36, v9
    v_add_f32 v9, 0x41880000, v8
    v_mul_f32 v9, v9, v6
    v_cos_f32 v33, v9
    v_sin_f32 v37, v9
    v_add_f32 v9, 0x41a00000, v8
    v_mul_f32 v9, v9, v6
    v_cos_f32 v34, v9
    v_sin_f32 v38, v9
    v_add_f32 v9, 0x41a80000, v8
    v_mul_f32 v9, v9, v6
    v_cos_f32 v35, v9
    v_sin_f32 v39, v9
    v_cvt_pk_bf16_f32 v20, v32, v36
    v_cvt_pk_bf16_f32 v21, v33, v37
    v_cvt_pk_bf16_f32 v22, v34, v38
    v_cvt_pk_bf16_f32 v23, v35, v39
    v_add_f32 v9, 0x42000000, v8
    v_mul_f32 v9, v9, v6
    v_cos_f32 v32, v9
    v_sin_f32 v36, v9
    v_add_f32 v9, 0x42040000, v8
    v_mul_f32 v9, v9, v6
    v_cos_f32 v33, v9
    v_sin_f32 v37, v9
    v_add_f32 v9, 0x42100000, v8
    v_mul_f32 v9, v9, v6
    v_cos_f32 v34, v9
    v_sin_f32 v38, v9
    v_add_f32 v9, 0x42140000, v8
    v_mul_f32 v9, v9, v6
    v_cos_f32 v35, v9
    v_sin_f32 v39, v9
    v_cvt_pk_bf16_f32 v24, v32, v36
    v_cvt_pk_bf16_f32 v25, v33, v37
    v_cvt_pk_bf16_f32 v26, v34, v38
    v_cvt_pk_bf16_f32 v27, v35, v39
    v_add_f32 v9, 0x42400000, v8
    v_mul_f32 v9, v9, v6
    v_cos_f32 v32, v9
    v_sin_f32 v36, v9
    v_add_f32 v9, 0x42440000, v8
    v_mul_f32 v9, v9, v6
    v_cos_f32 v33, v9
    v_sin_f32 v37, v9
    v_add_f32 v9, 0x42500000, v8
    v_mul_f32 v9, v9, v6
    v_cos_f32 v34, v9
    v_sin_f32 v38, v9
    v_add_f32 v9, 0x42540000, v8
    v_mul_f32 v9, v9, v6
    v_cos_f32 v35, v9
    v_sin_f32 v39, v9
    v_cvt_pk_bf16_f32 v28, v32, v36
    v_cvt_pk_bf16_f32 v29, v33, v37
    v_cvt_pk_bf16_f32 v30, v34, v38
    v_cvt_pk_bf16_f32 v31, v35, v39
    v_and_b32 v9, 1, v5
    v_lshlrev_b32 v9, 31, v9
    v_or_b32 v9, 0x3f803f80, v9
    v_cmp_gt_u32 vcc, 16, v1
    s_nop 1
    v_cndmask_b32 v16, v16, v9, vcc
    v_lshlrev_b32 v44, 2, v7
    v_add_u32 v44, 71936, v44
    v_lshrrev_b32 v8, 3, v2
    v_add_u32 v7, v7, v8
    v_and_b32 v9, 3, v7
    v_lshlrev_b32 v7, 8, v7
    v_lshl_add_u32 v7, v9, 6, v7
    v_and_b32 v8, 3, v2
    v_lshl_add_u32 v7, v8, 4, v7
    v_lshrrev_b32 v8, 2, v2
    v_and_b32 v8, 1, v8
    v_lshl_add_u32 v7, v8, 3, v7
    v_add_u32 v40, 55552, v7
    v_xor_b32 v41, 64, v40
    v_xor_b32 v42, 0x80, v40
    v_xor_b32 v43, 0xc0, v40
    s_lshl_b32 s36, s3, 8
    s_add_u32 s36, s36, s29
    v_lshl_add_u32 v5, v3, 6, s36
    v_mul_u32_u24 v13, 2560, v5
    v_lshl_add_u32 v13, v2, 3, v13
    s_lshl_b32 s37, s30, 7
    s_add_u32 s38, s37, 40960
    s_add_u32 s39, s38, 40960
    s_add_u32 s40, s39, 40960
    s_sub_u32 s41, 1272, s37
    v_lshlrev_b32 v8, 3, v2
    v_sub_u32 v8, s41, v8
    v_sub_u32 v6, 2048, v5
    v_and_b32 v7, 2047, v6
    v_mul_u32_u24 v14, 2560, v7
    v_add_u32 v14, v14, v8
    v_subrev_u32 v6, 48, v6
    v_mul_u32_u24 v15, 2560, v6
    v_add_u32 v15, v15, v8
    s_mov_b32 s42, 40960
    s_mov_b32 s43, 81920
    s_lshl_b32 s31, s28, 14
    s_lshl_b32 s32, s3, 11
    s_add_u32 s31, s31, s32
    s_add_u32 s31, s31, 5242880
    s_add_u32 m0, s32, 55552
    v_lshlrev_b32 v10, 4, v1
    v_lshlrev_b32 v11, 7, v1
    v_lshlrev_b32 v12, 9, v1
    s_lshr_b32 s33, s30, 2
    s_lshl_b32 s33, s33, 8
    s_lshl_b32 s34, s29, 4
    s_add_u32 s33, s33, s34
    s_and_b32 s34, s30, 3
    s_lshl_b32 s34, s34, 2
    s_add_u32 s33, s33, s34
    s_add_u32 s33, s33, 6553600
    s_cmp_lg_u32 s3, 7
    s_cbranch_scc1 A_nopoll
    s_mov_b32 s62, 40000
    s_branch PS_20
PL_18:
    s_sleep 4
PS_20:
    buffer_load_dword v4, v11, s[12:15], s44 offen offset:0 sc1
    s_sub_u32 s62, s62, 1
    s_cbranch_scc1 PD_19
    s_waitcnt vmcnt(0)
    v_cmp_ne_u32 vcc, s60, v4
    s_cbranch_vccnz PL_18
PD_19:
A_nopoll:
    s_barrier
    buffer_load_dwordx4 v10, s[12:15], s31 offen sc1 lds
    buffer_load_dwordx4 v10, s[12:15], s31 offen offset:1024 sc1 lds
    s_cmp_lg_u32 s3, 7
    s_cbranch_scc1 A2_no3
    s_mov_b32 m0, 71936
    s_nop 0
    buffer_load_dword v12, s[12:15], s33 offen sc1 lds
A2_no3:
    s_waitcnt vmcnt(0)
    s_barrier
    ds_read_b64_tr_b16 v[48:49], v40 offset:0
    ds_read_b64_tr_b16 v[50:51], v40 offset:1024
    ds_read_b64_tr_b16 v[52:53], v41 offset:0
    ds_read_b64_tr_b16 v[54:55], v41 offset:1024
    ds_read_b64_tr_b16 v[56:57], v42 offset:0
    ds_read_b64_tr_b16 v[58:59], v42 offset:1024
    ds_read_b64_tr_b16 v[60:61], v43 offset:0
    ds_read_b64_tr_b16 v[62:63], v43 offset:1024
    ds_read_b64 v[64:65], v44 offset:0
    ds_read_b64 v[66:67], v44 offset:16
    s_waitcnt lgkmcnt(5)
    ds_read_b64_tr_b16 v[68:69], v40 offset:4096
    ds_read_b64_tr_b16 v[70:71], v40 offset:5120
    ds_read_b64_tr_b16 v[72:73], v41 offset:4096
    ds_read_b64_tr_b16 v[74:75], v41 offset:5120
    ds_read_b64_tr_b16 v[76:77], v42 offset:4096
    ds_read_b64_tr_b16 v[78:79], v42 offset:5120
    ds_read_b64_tr_b16 v[80:81], v43 offset:4096
    ds_read_b64_tr_b16 v[82:83], v43 offset:5120
    ds_read_b64 v[84:85], v44 offset:64
    ds_read_b64 v[86:87], v44 offset:80
    s_waitcnt lgkmcnt(10)
    v_mfma_f32_16x16x32_bf16 v[128:131], v[16:19], v[48:51], 0
    v_mfma_f32_16x16x32_bf16 v[144:147], v[16:19], v[64:67], 0
    v_mfma_f32_16x16x32_bf16 v[132:135], v[16:19], v[52:55], 0
    v_mfma_f32_16x16x32_bf16 v[136:139], v[16:19], v[56:59], 0
    v_mfma_f32_16x16x32_bf16 v[140:143], v[16:19], v[60:63], 0
    s_waitcnt lgkmcnt(5)
    ds_read_b64_tr_b16 v[88:89], v40 offset:8192
    ds_read_b64_tr_b16 v[90:91], v40 offset:9216
    ds_read_b64_tr_b16 v[92:93], v41 offset:8192
    ds_read_b64_tr_b16 v[94:95], v41 offset:9216
    ds_read_b64_tr_b16 v[96:97], v42 offset:8192
    ds_read_b64_tr_b16 v[98:99], v42 offset:9216
    ds_read_b64_tr_b16 v[100:101], v43 offset:8192
    ds_read_b64_tr_b16 v[102:103], v43 offset:9216
    ds_read_b64 v[104:105], v44 offset:128
    ds_read_b64 v[106:107], v44 offset:144
    s_waitcnt lgkmcnt(10)
    v_mfma_f32_16x16x32_bf16 v[128:131], v[20:23], v[68:71], v[128:131]
    v_mfma_f32_16x16x32_bf16 v[144:147], v[20:23], v[84:87], v[144:147]
    v_mfma_f32_16x16x32_bf16 v[132:135], v[20:23], v[72:75], v[132:135]
    v_mfma_f32_16x16x32_bf16 v[136:139], v[20:23], v[76:79], v[136:139]
    v_mfma_f32_16x16x32_bf16 v[140:143], v[20:23], v[80:83], v[140:143]
    s_waitcnt lgkmcnt(5)
    ds_read_b64_tr_b16 v[108:109], v40 offset:12288
    ds_read_b64_tr_b16 v[110:111], v40 offset:13312
    ds_read_b64_tr_b16 v[112:113], v41 offset:12288
    ds_read_b64_tr_b16 v[114:115], v41 offset:13312
    ds_read_b64_tr_b16 v[116:117], v42 offset:12288
    ds_read_b64_tr_b16 v[118:119], v42 offset:13312
    ds_read_b64_tr_b16 v[120:121], v43 offset:12288
    ds_read_b64_tr_b16 v[122:123], v43 offset:13312
    ds_read_b64 v[124:125], v44 offset:192
    ds_read_b64 v[126:127], v44 offset:208
    s_waitcnt lgkmcnt(10)
    v_mfma_f32_16x16x32_bf16 v[128:131], v[24:27], v[88:91], v[128:131]
    v_mfma_f32_16x16x32_bf16 v[144:147], v[24:27], v[104:107], v[144:147]
    v_mfma_f32_16x16x32_bf16 v[132:135], v[24:27], v[92:95], v[132:135]
    v_mfma_f32_16x16x32_bf16 v[136:139], v[24:27], v[96:99], v[136:139]
    v_mfma_f32_16x16x32_bf16 v[140:143], v[24:27], v[100:103], v[140:143]
    s_waitcnt lgkmcnt(0)
    v_mfma_f32_16x16x32_bf16 v[128:131], v[28:31], v[108:111], v[128:131]
    v_mfma_f32_16x16x32_bf16 v[144:147], v[28:31], v[124:127], v[144:147]
    v_mfma_f32_16x16x32_bf16 v[132:135], v[28:31], v[112:115], v[132:135]
    v_mfma_f32_16x16x32_bf16 v[136:139], v[28:31], v[116:119], v[136:139]
    v_mfma_f32_16x16x32_bf16 v[140:143], v[28:31], v[120:123], v[140:143]
    s_nop 4
    v_mov_b32_dpp v144, v128 row_shl:1 row_mask:0xf bank_mask:0xf
    v_mov_b32_dpp v145, v129 row_shl:1 row_mask:0xf bank_mask:0xf
    v_mov_b32_dpp v146, v130 row_shl:1 row_mask:0xf bank_mask:0xf
    v_mov_b32_dpp v147, v131 row_shl:1 row_mask:0xf bank_mask:0xf
    v_cvt_pk_bf16_f32 v48, v128, v132
    v_cvt_pk_bf16_f32 v49, v136, v140
    buffer_store_dwordx2 v[48:49], v13, s[16:19], s37 offen sc1
    v_cvt_pk_bf16_f32 v50, v144, v140
    v_cvt_pk_bf16_f32 v51, v136, v132
    buffer_store_dwordx2 v[50:51], v14, s[16:19], 0 offen sc1
    v_cvt_pk_bf16_f32 v52, v129, v133
    v_cvt_pk_bf16_f32 v53, v137, v141
    buffer_store_dwordx2 v[52:53], v13, s[16:19], s38 offen sc1
    v_cvt_pk_bf16_f32 v54, v145, v141
    v_cvt_pk_bf16_f32 v55, v137, v133
    buffer_store_dwordx2 v[54:55], v15, s[16:19], s43 offen sc1
    v_cvt_pk_bf16_f32 v56, v130, v134
    v_cvt_pk_bf16_f32 v57, v138, v142
    buffer_store_dwordx2 v[56:57], v13, s[16:19], s39 offen sc1
    v_cvt_pk_bf16_f32 v58, v146, v142
    v_cvt_pk_bf16_f32 v59, v138, v134
    buffer_store_dwordx2 v[58:59], v15, s[16:19], s42 offen sc1
    v_cvt_pk_bf16_f32 v60, v131, v135
    v_cvt_pk_bf16_f32 v61, v139, v143
    buffer_store_dwordx2 v[60:61], v13, s[16:19], s40 offen sc1
    v_cvt_pk_bf16_f32 v62, v147, v143
    v_cvt_pk_bf16_f32 v63, v139, v135
    buffer_store_dwordx2 v[62:63], v15, s[16:19], 0 offen sc1
    s_endpgm
K_end:
    s_endpgm
.section .rodata,"a"
.p2align 6
.amdhsa_kernel concat_heads__spectral_fnet__ssm_conv_h3__prompt_kernel
  .amdhsa_next_free_vgpr 224
  .amdhsa_next_free_sgpr 64
  .amdhsa_accum_offset 224
  .amdhsa_group_segment_fixed_size 0
  .amdhsa_kernarg_size 112
  .amdhsa_user_sgpr_count 2
  .amdhsa_user_sgpr_kernarg_segment_ptr 1
  .amdhsa_system_sgpr_workgroup_id_x 1
.end_amdhsa_kernel
```
